```python
import torch

def _softmax(x, axis=-1):
    return torch.softmax(x, dim=axis)

def _gelu(x):
    return torch.nn.functional.gelu(x, approximate='tanh')

def _silu(x):
    return torch.nn.functional.silu(x)

def _sigmoid(x):
    return torch.sigmoid(x)

def _layernorm(x, axis=-1, eps=1e-05):
    m = x.mean(dim=axis, keepdim=True)
    v = x.var(dim=axis, keepdim=True, unbiased=False)
    return (x - m) / torch.sqrt(v + eps)

def _scatter_add(tgt, idx, src, axis=0):
    return tgt.clone().index_add_(axis, idx, src)

def _segment_sum(src, seg, n):
    out = torch.zeros((n,) + src.shape[1:], dtype=src.dtype)
    return out.index_add_(0, seg, src)

def _pad(x, pw):
    flat = tuple((v for pair in reversed(pw) for v in pair))
    return torch.nn.functional.pad(x, flat)
kernel_name = 'adaLN_cond__ssm_conv_h3__moe_arch_mod__prompt'

def setup_inputs():

    _w = lambda a: (lambda t: t.to(torch.bfloat16) if t.is_floating_point() else t)(torch.as_tensor(a))

    def _A_setup():
        B, S, D = (1, 2048, 640)
        ks = 4
        return {'q': _w((lambda *s: torch.randn(*s, dtype=torch.bfloat16) * 0.05)(B, S, D)), 'k': _w((lambda *s: torch.randn(*s, dtype=torch.bfloat16) * 0.4)(B, S, D)), 'v': _w((lambda *s: torch.randn(*s, dtype=torch.bfloat16) * 0.4)(B, S, D)), 'shift_k': _w((lambda *s: torch.randn(*s, dtype=torch.bfloat16) * 0.4)(D, ks) * 0.5), 'ssm_k': _w((lambda *s: torch.randn(*s, dtype=torch.bfloat16) * 0.8)(D, S) * (1.0 / S ** 0.5)), 'ssm_D': _w((lambda *s: torch.randn(*s, dtype=torch.bfloat16) * 0.4)(D))}
    _A_in = _A_setup()

    def _B_setup():
        B, S, D, F, C = (1, 2048, 640, 1728, 2)
        return {'x': _w((lambda *s: torch.randn(*s, dtype=torch.bfloat16) * 0.05)(B, S, D)), 'w_r': _w((lambda *s: torch.randn(*s, dtype=torch.bfloat16) * 0.05)(D)), 'w_gate': _w((lambda *s: torch.randn(*s, dtype=torch.bfloat16) * 0.05)(D, F)), 'w_up': _w((lambda *s: torch.randn(*s, dtype=torch.bfloat16) * 0.05)(D, F)), 'w_down': _w((lambda *s: torch.randn(*s, dtype=torch.bfloat16) * 0.05)(F, D))}
    _B_in = _B_setup()
    return {'A_q': _A_in['q'], 'A_k': _A_in['k'], 'A_v': _A_in['v'], 'A_shift_k': _A_in['shift_k'], 'A_ssm_k': _A_in['ssm_k'], 'A_ssm_D': _A_in['ssm_D'], 'B_x': _B_in['x'], 'B_w_r': _B_in['w_r'], 'B_w_gate': _B_in['w_gate'], 'B_w_up': _B_in['w_up'], 'B_w_down': _B_in['w_down'], 'c': _w((lambda *s: torch.randn(*s, dtype=torch.bfloat16) * 0.2)(1, 640) * 8.0), 'w_mod': _w((lambda *s: torch.randn(*s, dtype=torch.bfloat16) * 0.2)(640, 6 * 640) * 640 ** (-0.5) * 8.0)}

def reference(A_q, A_k, A_v, A_shift_k, A_ssm_k, A_ssm_D, B_x, B_w_r, B_w_gate, B_w_up, B_w_down, c, w_mod):

    def _A_ref(q, k, v, shift_k, ssm_k, ssm_D):
        B, S, D = q.shape
        ks = shift_k.shape[-1]
        k_pad = _pad(k, ((0, 0), (ks - 1, 0), (0, 0)))
        k_shift = torch.zeros_like(k)
        for t in range(ks):
            k_shift = k_shift + k_pad[:, t:t + S, :] * shift_k[:, ks - 1 - t][None, None, :]
        kv = k_shift * v
        L = 2 * S
        kv_pad = _pad(kv, ((0, 0), (0, S), (0, 0)))
        kf_pad = _pad(ssm_k, ((0, 0), (0, S)))
        kv_f = (lambda x, axes=(-2, -1): torch.fft.rfft2(x.float(), dim=axes))(kv_pad[:, None, :, :], axes=(1, 2))
        kf_f = (lambda x, axes=(-2, -1): torch.fft.rfft2(x.float(), dim=axes))(kf_pad[:, None, :], axes=(1, 2))
        kf_f = (lambda x, *d: x.permute(*d))(kf_f, 1, 2, 0)
        y_f = kv_f * kf_f[None, :, :, :]
        y = (lambda x, s, axes=(-2, -1): torch.fft.irfft2(x, s=s, dim=axes).to(torch.bfloat16))(y_f, (1, L), axes=(1, 2))[:, 0, :S, :]
        y = y + kv * ssm_D[None, None, :]
        return q * y

    def _B_ref(x, w_r, w_gate, w_up, w_down):
        B, S, D = x.shape
        C = 2
        r = x @ w_r
        idx = torch.argsort(-r, axis=-1)[:, :C]
        idx_e = (lambda x, n, axis: torch.repeat_interleave(x, n, dim=axis))(idx.reshape(B, C, 1), D, axis=2)
        x_sel = (lambda x, i, axis: torch.take_along_dim(x, i, dim=axis))(x, idx_e, axis=1)
        g = _silu(x_sel @ w_gate)
        u = x_sel @ w_up
        y = g * u @ w_down
        r_sel = _sigmoid((lambda x, i, axis: torch.take_along_dim(x, i, dim=axis))(r, idx, axis=1))
        y = y * r_sel.reshape(B, C, 1)
        b_off = (torch.arange(B) * S).reshape(B, 1)
        flat_idx = (idx + b_off).reshape(B * C)
        zero = (x * 0.0).reshape(B * S, D)
        upd = _scatter_add(zero, flat_idx, y.reshape(B * C, D), axis=0)
        return x + upd.reshape(B, S, D)
    x = A_q
    mod = (_silu(c) @ w_mod).reshape(c.shape[0], 6, 1, -1)
    sa, ca, ga, sb, cb, gb = (mod[:, 0].clone(), mod[:, 1].clone(), mod[:, 2].clone(), mod[:, 3].clone(), mod[:, 4].clone(), mod[:, 5].clone())
    h = _layernorm(x, axis=-1) * (1 + ca) + sa
    x = x + ga * _A_ref(h, A_k, A_v, A_shift_k, A_ssm_k, A_ssm_D)
    h = _layernorm(x, axis=-1) * (1 + cb) + sb
    x = x + gb * _B_ref(h, B_w_r, B_w_gate, B_w_up, B_w_down)
    return x
```

```asm
; @launch grid=(256,1,1) block=(320,1,1) lds=163840
.amdgcn_target "amdgcn-amd-amdhsa--gfx950"
.text
.globl adaLN_cond__ssm_conv_h3__moe_arch_mod__prompt_kernel
.p2align 8
.type adaLN_cond__ssm_conv_h3__moe_arch_mod__prompt_kernel,@function
adaLN_cond__ssm_conv_h3__moe_arch_mod__prompt_kernel:
.set CODE_LEFT, L_exit - L_pcbase
    s_cmp_ge_u32 s2, 256
    s_cbranch_scc1 L_exit
    s_load_dwordx16 s[16:31], s[0:1], 0
    s_load_dwordx16 s[32:47], s[0:1], 64
    s_getpc_b64 s[84:85]
L_pcbase:
    s_lshr_b32 s10, s2, 3
    s_lshl_b32 s10, s10, 10
    v_and_b32 v6, 7, v0
    v_lshlrev_b32 v6, 7, v6
    v_add_u32 v6, s10, v6
    v_min_u32 v6, CODE_LEFT, v6
    global_load_dword v135, v6, s[84:85]
    s_and_b32 s10, s2, 7
    s_lshr_b32 s11, s2, 6
    s_lshl_b32 s11, s11, 3
    s_add_u32 s5, s10, s11
    s_bfe_u32 s6, s2, 0x30003
    v_and_b32 v1, 63, v0
    v_lshrrev_b32 v2, 6, v0
    s_mul_i32 s10, s5, 81920
    v_readfirstlane_b32 s3, v2
    s_mul_i32 s11, s6, 160
    s_add_u32 s10, s10, s11
    s_mov_b32 s50, 2621440
    s_mov_b32 s51, 0x20000
    s_mov_b32 s54, 2621440
    s_mov_b32 s55, 0x20000
    v_lshrrev_b32 v4, 3, v0
    s_mul_i32 s12, s6, 640
    v_lshlrev_b32 v120, 4, v4
    v_add_u32 v120, s12, v120
    v_mov_b32 v239, 0
    s_cmp_eq_u32 s3, 4
    s_cbranch_scc1 L_p4
    v_lshl_add_u32 v10, v2, 6, v1
    v_add_u32 v11, 256, v10
    v_and_b32 v12, 64, v10
    v_add3_u32 v12, v12, v1, v1
    v_sub_u32 v12, v12, v1
    v_add_u32 v12, 512, v12
    v_mul_u32_u24 v14, 6554, v10
    v_mul_u32_u24 v15, 6554, v11
    v_mul_u32_u24 v16, 6554, v12
    v_lshrrev_b32 v14, 16, v14
    v_lshrrev_b32 v15, 16, v15
    v_lshrrev_b32 v16, 16, v16
    v_mul_u32_u24 v18, 10, v14
    v_mul_u32_u24 v19, 10, v15
    v_mul_u32_u24 v20, 10, v16
    v_sub_u32 v10, v10, v18
    v_sub_u32 v11, v11, v19
    v_sub_u32 v12, v12, v20
    v_lshrrev_b32 v18, 3, v14
    v_sub_u32 v10, v10, v18
    v_lshrrev_b32 v19, 3, v15
    v_sub_u32 v11, v11, v19
    v_lshrrev_b32 v20, 3, v16
    v_sub_u32 v12, v12, v20
    v_add_u32 v10, 9, v10
    v_subrev_u32 v18, 10, v10
    v_add_u32 v11, 9, v11
    v_subrev_u32 v19, 10, v11
    v_add_u32 v12, 9, v12
    v_subrev_u32 v20, 10, v12
    v_min_u32 v10, v10, v18
    v_min_u32 v11, v11, v19
    v_min_u32 v12, v12, v20
    v_mul_u32_u24 v14, 1280, v14
    v_mul_u32_u24 v15, 1280, v15
    v_mul_u32_u24 v16, 1280, v16
    v_lshl_add_u32 v10, v10, 4, v14
    v_lshl_add_u32 v11, v11, 4, v15
    v_lshl_add_u32 v12, v12, 4, v16
    v_mul_u32_u24 v6, 6554, v1
    v_lshrrev_b32 v6, 16, v6
    v_mul_u32_u24 v6, 1120, v6
    v_lshl_add_u32 v6, v1, 4, v6
    s_sub_u32 s13, s10, 3840
    s_cmp_eq_u32 s5, 0
    s_cselect_b32 s13, 2147483648, s13
    s_lshl_b32 s11, s3, 10
    s_add_u32 s11, s11, 140544
    s_and_b32 s12, s3, 1
    s_lshl_b32 s12, s12, 10
    s_lshr_b32 s14, s3, 1
    s_mul_i32 s14, s14, 10240
    s_add_u32 s14, s14, s12
    s_add_u32 s14, s14, 148736
    s_mov_b32 s74, 2621440
    s_mov_b32 s75, 0x20000
    s_cmp_ge_u32 s3, 2
    s_waitcnt lgkmcnt(0)
    s_cselect_b64 s[72:73], s[20:21], s[18:19]
    s_mov_b64 s[48:49], s[18:19]
    s_mov_b64 s[52:53], s[20:21]
    s_cmp_lg_u32 s3, 0
    s_cbranch_scc1 L_nohalo
    s_mov_b32 m0, 140064
    s_mov_b64 exec, 0x3fffffff
    buffer_load_dwordx4 v6, s[48:51], s13 offen lds
    s_mov_b64 exec, -1
L_nohalo:
    s_mov_b32 m0, s11
    s_add_u32 s12, s11, 4096
    buffer_load_dwordx4 v10, s[48:51], s10 offen nt lds
    s_mov_b32 m0, s12
    s_add_u32 s11, s11, 10240
    buffer_load_dwordx4 v11, s[48:51], s10 offen nt lds
    s_mov_b32 m0, s14
    s_add_u32 s12, s12, 10240
    buffer_load_dwordx4 v12, s[72:75], s10 offen nt lds
    s_mov_b32 m0, s11
    s_nop 0
    buffer_load_dwordx4 v10, s[52:55], s10 offen nt lds
    s_mov_b32 m0, s12
    s_nop 0
    buffer_load_dwordx4 v11, s[52:55], s10 offen nt lds
    global_load_dwordx4 v[112:115], v120, s[22:23]
    s_branch L_p5
L_p4:
    s_mul_i32 s11, s2, 1093
    s_lshr_b32 s11, s11, 16
    s_mul_i32 s12, s11, 60
    s_sub_u32 s12, s2, s12
    s_lshl_b32 s88, s12, 2
    s_add_u32 s88, s88, s11
    s_mul_i32 s13, s11, 1228800
    s_lshl_b32 s12, s12, 7
    s_add_u32 s13, s13, s12
    v_lshrrev_b32 v10, 3, v1
    v_mul_u32_u24 v11, 7680, v10
    v_and_b32 v12, 7, v1
    v_lshl_add_u32 v11, v12, 4, v11
    s_mul_i32 s12, s11, 320
    v_lshlrev_b32 v12, 2, v1
    s_mov_b32 s74, 4915200
    s_mov_b32 s75, 0x20000
    s_mov_b32 s78, 1280
    s_mov_b32 s79, 0x20000
    s_waitcnt lgkmcnt(0)
    s_mov_b64 s[72:73], s[40:41]
    s_mov_b64 s[76:77], s[38:39]
    global_load_dwordx4 v[112:115], v120, s[22:23]
    buffer_load_dword v220, v12, s[76:79], s12 offen
    buffer_load_dword v221, v12, s[76:79], s12 offen offset:256
    s_mov_b32 s89, s13
    v_mov_b32 v239, v11
L_p5:
    v_bfrev_b32 v137, 1
    v_and_b32 v5, 7, v0
    v_sub_u32 v121, 7, v5
    v_lshlrev_b32 v121, 4, v121
    v_lshl_add_u32 v121, v4, 13, v121
    s_and_b32 s10, s2, 7
    s_lshr_b32 s11, s2, 3
    s_mul_i32 s12, s10, 20
    s_add_u32 s12, s12, s11
    s_sub_u32 s13, s11, 20
    s_lshl_b32 s13, s13, 3
    s_add_u32 s13, s13, s10
    s_add_u32 s14, s13, 160
    s_cmp_lt_u32 s11, 20
    s_cselect_b32 s7, s12, s13
    s_cselect_b32 s8, s12, s14
    s_cselect_b32 s9, 1, 0
    s_lshl_b32 s14, s7, 3
    s_load_dwordx2 s[80:81], s[26:27], s14
    s_mul_i32 s10, s6, 327680
    s_sub_u32 s11, 31, s5
    s_lshl_b32 s11, s11, 7
    s_add_u32 s10, s10, s11
    s_add_u32 s10, s10, 2097152
    v_add_u32 v121, s10, v121
    v_lshlrev_b32 v122, 4, v0
    s_mul_i32 s10, s2, 3840
    s_add_u32 s10, s10, 6881280
    v_add_u32 v123, s10, v122
    s_add_u32 s10, s7, 60
    s_cmp_lt_u32 s7, 128
    s_cselect_b32 s10, s7, s10
    s_add_u32 s11, s7, 40
    s_sub_u32 s12, s7, 56
    s_cmp_ge_u32 s7, 56
    s_cselect_b32 s83, s12, s11
    s_add_u32 s11, s83, 128
    s_add_u32 s12, s83, 160
    s_cmp_lt_u32 s83, 60
    s_cselect_b32 s11, s11, s12
    s_cmp_eq_u32 s9, 1
    s_cselect_b32 s10, s10, s11
    s_lshl_b32 s10, s10, 7
    s_add_u32 s10, s10, 33024
    v_add_u32 v125, s10, v122
    v_cmp_gt_u32 vcc, 240, v0
    s_nop 1
    v_cndmask_b32 v123, v125, v123, vcc
    s_mul_i32 s11, s2, 1093
    s_lshr_b32 s11, s11, 16
    s_mul_i32 s12, s11, 60
    s_sub_u32 s12, s2, s12
    s_lshl_b32 s12, s12, 2
    s_add_u32 s12, s12, s11
    s_lshl_b32 s12, s12, 8
    s_add_u32 s12, s12, 1437824
    s_cmp_lt_u32 s11, 4
    s_cselect_b32 s12, s12, 2147483648
    v_add_u32 v125, s12, v122
    v_cmp_gt_u32 vcc, 248, v0
    s_nop 1
    v_cndmask_b32 v123, v125, v123, vcc
    v_cmp_gt_u32 vcc, 264, v0
    s_nop 1
    v_cndmask_b32 v123, v137, v123, vcc
    s_mul_i32 s10, s8, 2560
    s_add_u32 s10, s10, 131072
    v_add_u32 v124, s10, v122
    v_cmp_gt_u32 vcc, 160, v0
    s_nop 1
    v_cndmask_b32 v124, v137, v124, vcc
    v_mov_b32 v28, -1
    v_mov_b32 v29, -1
    v_mov_b32 v30, -1
    v_mov_b32 v31, -1
    s_lshl_b32 s10, s7, 2
    s_add_u32 s10, s10, s3
    s_lshl_b32 s10, s10, 12
    s_cmp_lt_u32 s3, 4
    s_cselect_b32 s11, s9, 0
    s_cmp_eq_u32 s11, 1
    s_cselect_b32 s10, s10, 2147483648
    v_lshlrev_b32 v126, 4, v1
    v_add_u32 v126, s10, v126
    s_mov_b32 s56, s46
    s_mov_b32 s57, s47
    s_mov_b32 s58, 8388608
    s_mov_b32 s59, 0x20000
    s_mov_b32 s60, s24
    s_mov_b32 s61, s25
    s_mov_b32 s62, 2621440
    s_mov_b32 s63, 0x20000
    s_mov_b32 s68, s16
    s_mov_b32 s69, s17
    s_mov_b32 s70, 2621440
    s_mov_b32 s71, 0x20000
    s_mov_b32 s64, s42
    s_mov_b32 s65, s43
    s_mov_b32 s66, 2621440
    s_mov_b32 s67, 0x20000
    v_lshrrev_b32 v132, 3, v1
    v_lshlrev_b32 v132, 3, v132
    s_mul_i32 s10, s3, 320
    v_add_u32 v132, s10, v132
    v_and_b32 v133, 7, v1
    v_mul_u32_u24 v131, 1280, v133
    v_add_u32 v131, v131, v132
    s_mul_i32 s10, s8, 10240
    s_cmp_lt_u32 s3, 4
    s_cselect_b32 s10, s10, 2147483648
    v_add_u32 v131, s10, v131
    v_mov_b32 v134, 162752
    v_mov_b32 v118, 0
    v_mov_b32 v119, 0
    ds_write_b64 v134, v[118:119]
    ds_write_b64 v134, v[118:119] offset:8
    ds_write_b64 v134, v[118:119] offset:16
    ds_write_b64 v134, v[118:119] offset:24
    v_lshrrev_b32 v6, 2, v4
    v_add_u32 v6, v6, v5
    v_subrev_u32 v7, 10, v6
    v_min_u32 v7, v6, v7
    v_add_u32 v6, 1, v6
    v_subrev_u32 v8, 10, v6
    v_min_u32 v8, v6, v8
    v_and_b32 v9, 3, v4
    v_lshlrev_b32 v9, 2, v9
    v_mul_u32_u24 v10, 1280, v5
    v_add_u32 v9, v9, v10
    v_lshl_add_u32 v2, v7, 4, v9
    v_add_u32 v2, 140064, v2
    v_lshl_add_u32 v3, v8, 4, v9
    v_add_u32 v3, 140544, v3
    v_add_u32 v4, 640, v3
    v_add_u32 v5, 10240, v3
    v_add_u32 v6, 10880, v3
    s_waitcnt vmcnt(0) lgkmcnt(0)
    s_barrier
    ds_read2_b32 v[8:9], v2 offset0:0 offset1:40
    ds_read_b32 v10, v2 offset:320
    ds_read2_b32 v[12:13], v3 offset0:0 offset1:40
    ds_read2_b32 v[14:15], v3 offset0:80 offset1:120
    ds_read2_b32 v[16:17], v4 offset0:0 offset1:40
    ds_read2_b32 v[18:19], v4 offset0:80 offset1:120
    ds_read2_b32 v[20:21], v5 offset0:0 offset1:40
    ds_read2_b32 v[22:23], v5 offset0:80 offset1:120
    ds_read2_b32 v[24:25], v6 offset0:0 offset1:40
    ds_read2_b32 v[26:27], v6 offset0:80 offset1:120
    buffer_load_dword v139, off, s[56:59], 0 offset:0 sc1
    buffer_store_dwordx4 v[28:31], v123, s[56:59], 0 offen sc1
    buffer_load_dwordx4 v[34:37], v126, s[60:63], 0 offen offset:0 nt
    buffer_load_dwordx4 v[42:45], v126, s[60:63], 0 offen offset:1024 nt
    buffer_load_dwordx4 v[50:53], v126, s[60:63], 0 offen offset:2048 nt
    buffer_load_dwordx4 v[58:61], v126, s[60:63], 0 offen offset:3072 nt
    s_cmp_lg_u32 s3, 4
    s_cbranch_scc1 L_nowm
    buffer_load_dwordx4 v[140:143], v239, s[72:75], s89 offen nt
    s_add_u32 s89, s89, 61440
    buffer_load_dwordx4 v[144:147], v239, s[72:75], s89 offen nt
    s_add_u32 s89, s89, 61440
    buffer_load_dwordx4 v[148:151], v239, s[72:75], s89 offen nt
    s_add_u32 s89, s89, 61440
    buffer_load_dwordx4 v[152:155], v239, s[72:75], s89 offen nt
    s_add_u32 s89, s89, 61440
    buffer_load_dwordx4 v[156:159], v239, s[72:75], s89 offen nt
    s_add_u32 s89, s89, 61440
    buffer_load_dwordx4 v[160:163], v239, s[72:75], s89 offen nt
    s_add_u32 s89, s89, 61440
    buffer_load_dwordx4 v[164:167], v239, s[72:75], s89 offen nt
    s_add_u32 s89, s89, 61440
    buffer_load_dwordx4 v[168:171], v239, s[72:75], s89 offen nt
    s_add_u32 s89, s89, 61440
    buffer_load_dwordx4 v[172:175], v239, s[72:75], s89 offen nt
    s_add_u32 s89, s89, 61440
    buffer_load_dwordx4 v[176:179], v239, s[72:75], s89 offen nt
    s_add_u32 s89, s89, 61440
    buffer_load_dwordx4 v[180:183], v239, s[72:75], s89 offen nt
    s_add_u32 s89, s89, 61440
    buffer_load_dwordx4 v[184:187], v239, s[72:75], s89 offen nt
    s_add_u32 s89, s89, 61440
    buffer_load_dwordx4 v[188:191], v239, s[72:75], s89 offen nt
    s_add_u32 s89, s89, 61440
    buffer_load_dwordx4 v[192:195], v239, s[72:75], s89 offen nt
    s_add_u32 s89, s89, 61440
    buffer_load_dwordx4 v[196:199], v239, s[72:75], s89 offen nt
    s_add_u32 s89, s89, 61440
    buffer_load_dwordx4 v[200:203], v239, s[72:75], s89 offen nt
    s_add_u32 s89, s89, 61440
    buffer_load_dwordx4 v[204:207], v239, s[72:75], s89 offen nt
    s_add_u32 s89, s89, 61440
    buffer_load_dwordx4 v[208:211], v239, s[72:75], s89 offen nt
    s_add_u32 s89, s89, 61440
    buffer_load_dwordx4 v[212:215], v239, s[72:75], s89 offen nt
    s_add_u32 s89, s89, 61440
    buffer_load_dwordx4 v[216:219], v239, s[72:75], s89 offen nt
L_nowm:
    v_lshlrev_b32 v86, 16, v112
    v_lshlrev_b32 v87, 16, v114
    v_and_b32 v88, 0xffff0000, v112
    v_and_b32 v89, 0xffff0000, v114
    v_lshlrev_b32 v90, 16, v113
    v_lshlrev_b32 v91, 16, v115
    v_and_b32 v92, 0xffff0000, v113
    v_and_b32 v93, 0xffff0000, v115
    s_waitcnt lgkmcnt(4)
    v_lshlrev_b32 v64, 16, v8
    v_and_b32 v65, 0xffff0000, v8
    v_lshlrev_b32 v66, 16, v9
    v_and_b32 v67, 0xffff0000, v9
    v_lshlrev_b32 v68, 16, v10
    v_and_b32 v69, 0xffff0000, v10
    v_lshlrev_b32 v70, 16, v12
    v_and_b32 v71, 0xffff0000, v12
    v_lshlrev_b32 v72, 16, v13
    v_and_b32 v73, 0xffff0000, v13
    v_lshlrev_b32 v74, 16, v14
    v_and_b32 v75, 0xffff0000, v14
    v_lshlrev_b32 v76, 16, v15
    v_and_b32 v77, 0xffff0000, v15
    v_lshlrev_b32 v78, 16, v16
    v_and_b32 v79, 0xffff0000, v16
    v_lshlrev_b32 v80, 16, v17
    v_and_b32 v81, 0xffff0000, v17
    v_lshlrev_b32 v82, 16, v18
    v_and_b32 v83, 0xffff0000, v18
    v_lshlrev_b32 v84, 16, v19
    v_and_b32 v85, 0xffff0000, v19
    v_pk_mul_f32 v[94:95], v[64:65], v[92:93]
    v_pk_mul_f32 v[96:97], v[66:67], v[92:93]
    v_pk_mul_f32 v[98:99], v[68:69], v[92:93]
    v_pk_mul_f32 v[100:101], v[70:71], v[92:93]
    v_pk_mul_f32 v[102:103], v[72:73], v[92:93]
    v_pk_mul_f32 v[104:105], v[74:75], v[92:93]
    v_pk_mul_f32 v[106:107], v[76:77], v[92:93]
    v_pk_mul_f32 v[108:109], v[78:79], v[92:93]
    v_pk_fma_f32 v[94:95], v[66:67], v[90:91], v[94:95]
    v_pk_fma_f32 v[96:97], v[68:69], v[90:91], v[96:97]
    v_pk_fma_f32 v[98:99], v[70:71], v[90:91], v[98:99]
    v_pk_fma_f32 v[100:101], v[72:73], v[90:91], v[100:101]
    v_pk_fma_f32 v[102:103], v[74:75], v[90:91], v[102:103]
    v_pk_fma_f32 v[104:105], v[76:77], v[90:91], v[104:105]
    v_pk_fma_f32 v[106:107], v[78:79], v[90:91], v[106:107]
    v_pk_fma_f32 v[108:109], v[80:81], v[90:91], v[108:109]
    v_pk_fma_f32 v[94:95], v[68:69], v[88:89], v[94:95]
    v_pk_fma_f32 v[96:97], v[70:71], v[88:89], v[96:97]
    v_pk_fma_f32 v[98:99], v[72:73], v[88:89], v[98:99]
    v_pk_fma_f32 v[100:101], v[74:75], v[88:89], v[100:101]
    v_pk_fma_f32 v[102:103], v[76:77], v[88:89], v[102:103]
    v_pk_fma_f32 v[104:105], v[78:79], v[88:89], v[104:105]
    v_pk_fma_f32 v[106:107], v[80:81], v[88:89], v[106:107]
    v_pk_fma_f32 v[108:109], v[82:83], v[88:89], v[108:109]
    v_pk_fma_f32 v[94:95], v[70:71], v[86:87], v[94:95]
    v_pk_fma_f32 v[96:97], v[72:73], v[86:87], v[96:97]
    v_pk_fma_f32 v[98:99], v[74:75], v[86:87], v[98:99]
    v_pk_fma_f32 v[100:101], v[76:77], v[86:87], v[100:101]
    v_pk_fma_f32 v[102:103], v[78:79], v[86:87], v[102:103]
    v_pk_fma_f32 v[104:105], v[80:81], v[86:87], v[104:105]
    v_pk_fma_f32 v[106:107], v[82:83], v[86:87], v[106:107]
    v_pk_fma_f32 v[108:109], v[84:85], v[86:87], v[108:109]
    s_waitcnt lgkmcnt(0)
    v_lshlrev_b32 v64, 16, v20
    v_and_b32 v65, 0xffff0000, v20
    v_lshlrev_b32 v66, 16, v21
    v_and_b32 v67, 0xffff0000, v21
    v_lshlrev_b32 v68, 16, v22
    v_and_b32 v69, 0xffff0000, v22
    v_lshlrev_b32 v70, 16, v23
    v_and_b32 v71, 0xffff0000, v23
    v_lshlrev_b32 v72, 16, v24
    v_and_b32 v73, 0xffff0000, v24
    v_lshlrev_b32 v74, 16, v25
    v_and_b32 v75, 0xffff0000, v25
    v_lshlrev_b32 v76, 16, v26
    v_and_b32 v77, 0xffff0000, v26
    v_lshlrev_b32 v78, 16, v27
    v_and_b32 v79, 0xffff0000, v27
    v_pk_mul_f32 v[94:95], v[94:95], v[64:65]
    v_pk_mul_f32 v[96:97], v[96:97], v[66:67]
    v_pk_mul_f32 v[98:99], v[98:99], v[68:69]
    v_pk_mul_f32 v[100:101], v[100:101], v[70:71]
    v_pk_mul_f32 v[102:103], v[102:103], v[72:73]
    v_pk_mul_f32 v[104:105], v[104:105], v[74:75]
    v_pk_mul_f32 v[106:107], v[106:107], v[76:77]
    v_pk_mul_f32 v[108:109], v[108:109], v[78:79]
    v_cvt_pk_bf16_f32 v112, v108, v106
    v_cvt_pk_bf16_f32 v113, v104, v102
    v_cvt_pk_bf16_f32 v114, v100, v98
    v_cvt_pk_bf16_f32 v115, v96, v94
    v_cvt_pk_bf16_f32 v116, v109, v107
    v_cvt_pk_bf16_f32 v117, v105, v103
    v_cvt_pk_bf16_f32 v118, v101, v99
    v_cvt_pk_bf16_f32 v119, v97, v95
    s_movk_i32 s10, 4096
    buffer_store_dwordx4 v[112:115], v121, s[56:59], 0 offen sc1
    buffer_store_dwordx4 v[116:119], v121, s[56:59], s10 offen sc1
    s_lshl_b32 s10, s5, 6
    s_lshl_b32 s11, s6, 11
    s_add_u32 s10, s10, s11
    s_add_u32 s10, s10, 4096
    v_mov_b32 v138, s10
    s_cmp_lg_u32 s3, 4
    s_cbranch_scc1 L_nogemv
    s_mov_b32 s10, 0xbfb8aa3b
    v_lshlrev_b32 v4, 16, v220
    v_and_b32 v5, 0xffff0000, v220
    v_lshlrev_b32 v6, 16, v221
    v_and_b32 v7, 0xffff0000, v221
    v_mul_f32 v8, s10, v4
    v_mul_f32 v9, s10, v5
    v_mul_f32 v10, s10, v6
    v_mul_f32 v11, s10, v7
    v_exp_f32 v8, v8
    v_exp_f32 v9, v9
    v_exp_f32 v10, v10
    v_exp_f32 v11, v11
    v_add_f32 v8, 1.0, v8
    v_add_f32 v9, 1.0, v9
    v_add_f32 v10, 1.0, v10
    v_add_f32 v11, 1.0, v11
    v_rcp_f32 v8, v8
    v_rcp_f32 v9, v9
    v_rcp_f32 v10, v10
    v_rcp_f32 v11, v11
    v_mul_f32 v4, v4, v8
    v_mul_f32 v5, v5, v9
    v_mul_f32 v6, v6, v10
    v_mul_f32 v7, v7, v11
    v_cvt_pk_bf16_f32 v8, v4, v5
    v_cvt_pk_bf16_f32 v9, v6, v7
    v_lshlrev_b32 v4, 16, v8
    v_and_b32 v5, 0xffff0000, v8
    v_lshlrev_b32 v6, 16, v9
    v_and_b32 v7, 0xffff0000, v9
    v_lshlrev_b32 v8, 3, v1
    v_add_u32 v8, 119488, v8
    ds_write_b64 v8, v[4:5]
    ds_write_b64 v8, v[6:7] offset:512
    v_lshrrev_b32 v8, 3, v1
    v_lshlrev_b32 v8, 2, v8
    v_add_u32 v8, 119488, v8
    ds_read_b32 v220, v8 offset:0
    ds_read_b32 v221, v8 offset:32
    ds_read_b32 v222, v8 offset:64
    ds_read_b32 v223, v8 offset:96
    ds_read_b32 v224, v8 offset:128
    ds_read_b32 v225, v8 offset:160
    ds_read_b32 v226, v8 offset:192
    ds_read_b32 v227, v8 offset:224
    ds_read_b32 v228, v8 offset:256
    ds_read_b32 v229, v8 offset:288
    ds_read_b32 v230, v8 offset:320
    ds_read_b32 v231, v8 offset:352
    ds_read_b32 v232, v8 offset:384
    ds_read_b32 v233, v8 offset:416
    ds_read_b32 v234, v8 offset:448
    ds_read_b32 v235, v8 offset:480
    ds_read_b32 v236, v8 offset:512
    ds_read_b32 v237, v8 offset:544
    ds_read_b32 v238, v8 offset:576
    ds_read_b32 v239, v8 offset:608
L_nogemv:
    s_cmp_lg_u32 s3, 0
    s_waitcnt vmcnt(0) lgkmcnt(0)
    v_add_u32 v139, 1, v139
    s_barrier
    v_readfirstlane_b32 s4, v139
    s_cbranch_scc1 L_noflag
    s_mov_b64 exec, 1
    buffer_store_dword v139, v138, s[56:59], 0 offen sc1
    s_mov_b64 exec, -1
L_noflag:
    s_cmp_lg_u32 s3, 4
    s_cbranch_scc1 L_nopart
    v_lshlrev_b32 v248, 16, v140
    v_and_b32 v249, 0xffff0000, v140
    v_lshlrev_b32 v250, 16, v141
    v_and_b32 v251, 0xffff0000, v141
    v_lshlrev_b32 v252, 16, v142
    v_and_b32 v253, 0xffff0000, v142
    v_lshlrev_b32 v254, 16, v143
    v_and_b32 v255, 0xffff0000, v143
    v_pk_mul_f32 v[240:241], v[248:249], v[220:221] op_sel_hi:[1,0]
    v_pk_mul_f32 v[242:243], v[250:251], v[220:221] op_sel_hi:[1,0]
    v_pk_mul_f32 v[244:245], v[252:253], v[220:221] op_sel_hi:[1,0]
    v_pk_mul_f32 v[246:247], v[254:255], v[220:221] op_sel_hi:[1,0]
    v_lshlrev_b32 v248, 16, v144
    v_and_b32 v249, 0xffff0000, v144
    v_lshlrev_b32 v250, 16, v145
    v_and_b32 v251, 0xffff0000, v145
    v_lshlrev_b32 v252, 16, v146
    v_and_b32 v253, 0xffff0000, v146
    v_lshlrev_b32 v254, 16, v147
    v_and_b32 v255, 0xffff0000, v147
    v_pk_fma_f32 v[240:241], v[248:249], v[220:221], v[240:241] op_sel:[0,1,0] op_sel_hi:[1,1,1]
    v_pk_fma_f32 v[242:243], v[250:251], v[220:221], v[242:243] op_sel:[0,1,0] op_sel_hi:[1,1,1]
    v_pk_fma_f32 v[244:245], v[252:253], v[220:221], v[244:245] op_sel:[0,1,0] op_sel_hi:[1,1,1]
    v_pk_fma_f32 v[246:247], v[254:255], v[220:221], v[246:247] op_sel:[0,1,0] op_sel_hi:[1,1,1]
    v_lshlrev_b32 v248, 16, v148
    v_and_b32 v249, 0xffff0000, v148
    v_lshlrev_b32 v250, 16, v149
    v_and_b32 v251, 0xffff0000, v149
    v_lshlrev_b32 v252, 16, v150
    v_and_b32 v253, 0xffff0000, v150
    v_lshlrev_b32 v254, 16, v151
    v_and_b32 v255, 0xffff0000, v151
    v_pk_fma_f32 v[240:241], v[248:249], v[222:223], v[240:241] op_sel:[0,0,0] op_sel_hi:[1,0,1]
    v_pk_fma_f32 v[242:243], v[250:251], v[222:223], v[242:243] op_sel:[0,0,0] op_sel_hi:[1,0,1]
    v_pk_fma_f32 v[244:245], v[252:253], v[222:223], v[244:245] op_sel:[0,0,0] op_sel_hi:[1,0,1]
    v_pk_fma_f32 v[246:247], v[254:255], v[222:223], v[246:247] op_sel:[0,0,0] op_sel_hi:[1,0,1]
    v_lshlrev_b32 v248, 16, v152
    v_and_b32 v249, 0xffff0000, v152
    v_lshlrev_b32 v250, 16, v153
    v_and_b32 v251, 0xffff0000, v153
    v_lshlrev_b32 v252, 16, v154
    v_and_b32 v253, 0xffff0000, v154
    v_lshlrev_b32 v254, 16, v155
    v_and_b32 v255, 0xffff0000, v155
    v_pk_fma_f32 v[240:241], v[248:249], v[222:223], v[240:241] op_sel:[0,1,0] op_sel_hi:[1,1,1]
    v_pk_fma_f32 v[242:243], v[250:251], v[222:223], v[242:243] op_sel:[0,1,0] op_sel_hi:[1,1,1]
    v_pk_fma_f32 v[244:245], v[252:253], v[222:223], v[244:245] op_sel:[0,1,0] op_sel_hi:[1,1,1]
    v_pk_fma_f32 v[246:247], v[254:255], v[222:223], v[246:247] op_sel:[0,1,0] op_sel_hi:[1,1,1]
    v_lshlrev_b32 v248, 16, v156
    v_and_b32 v249, 0xffff0000, v156
    v_lshlrev_b32 v250, 16, v157
    v_and_b32 v251, 0xffff0000, v157
    v_lshlrev_b32 v252, 16, v158
    v_and_b32 v253, 0xffff0000, v158
    v_lshlrev_b32 v254, 16, v159
    v_and_b32 v255, 0xffff0000, v159
    v_pk_fma_f32 v[240:241], v[248:249], v[224:225], v[240:241] op_sel:[0,0,0] op_sel_hi:[1,0,1]
    v_pk_fma_f32 v[242:243], v[250:251], v[224:225], v[242:243] op_sel:[0,0,0] op_sel_hi:[1,0,1]
    v_pk_fma_f32 v[244:245], v[252:253], v[224:225], v[244:245] op_sel:[0,0,0] op_sel_hi:[1,0,1]
    v_pk_fma_f32 v[246:247], v[254:255], v[224:225], v[246:247] op_sel:[0,0,0] op_sel_hi:[1,0,1]
    v_lshlrev_b32 v248, 16, v160
    v_and_b32 v249, 0xffff0000, v160
    v_lshlrev_b32 v250, 16, v161
    v_and_b32 v251, 0xffff0000, v161
    v_lshlrev_b32 v252, 16, v162
    v_and_b32 v253, 0xffff0000, v162
    v_lshlrev_b32 v254, 16, v163
    v_and_b32 v255, 0xffff0000, v163
    v_pk_fma_f32 v[240:241], v[248:249], v[224:225], v[240:241] op_sel:[0,1,0] op_sel_hi:[1,1,1]
    v_pk_fma_f32 v[242:243], v[250:251], v[224:225], v[242:243] op_sel:[0,1,0] op_sel_hi:[1,1,1]
    v_pk_fma_f32 v[244:245], v[252:253], v[224:225], v[244:245] op_sel:[0,1,0] op_sel_hi:[1,1,1]
    v_pk_fma_f32 v[246:247], v[254:255], v[224:225], v[246:247] op_sel:[0,1,0] op_sel_hi:[1,1,1]
    v_lshlrev_b32 v248, 16, v164
    v_and_b32 v249, 0xffff0000, v164
    v_lshlrev_b32 v250, 16, v165
    v_and_b32 v251, 0xffff0000, v165
    v_lshlrev_b32 v252, 16, v166
    v_and_b32 v253, 0xffff0000, v166
    v_lshlrev_b32 v254, 16, v167
    v_and_b32 v255, 0xffff0000, v167
    v_pk_fma_f32 v[240:241], v[248:249], v[226:227], v[240:241] op_sel:[0,0,0] op_sel_hi:[1,0,1]
    v_pk_fma_f32 v[242:243], v[250:251], v[226:227], v[242:243] op_sel:[0,0,0] op_sel_hi:[1,0,1]
    v_pk_fma_f32 v[244:245], v[252:253], v[226:227], v[244:245] op_sel:[0,0,0] op_sel_hi:[1,0,1]
    v_pk_fma_f32 v[246:247], v[254:255], v[226:227], v[246:247] op_sel:[0,0,0] op_sel_hi:[1,0,1]
    v_lshlrev_b32 v248, 16, v168
    v_and_b32 v249, 0xffff0000, v168
    v_lshlrev_b32 v250, 16, v169
    v_and_b32 v251, 0xffff0000, v169
    v_lshlrev_b32 v252, 16, v170
    v_and_b32 v253, 0xffff0000, v170
    v_lshlrev_b32 v254, 16, v171
    v_and_b32 v255, 0xffff0000, v171
    v_pk_fma_f32 v[240:241], v[248:249], v[226:227], v[240:241] op_sel:[0,1,0] op_sel_hi:[1,1,1]
    v_pk_fma_f32 v[242:243], v[250:251], v[226:227], v[242:243] op_sel:[0,1,0] op_sel_hi:[1,1,1]
    v_pk_fma_f32 v[244:245], v[252:253], v[226:227], v[244:245] op_sel:[0,1,0] op_sel_hi:[1,1,1]
    v_pk_fma_f32 v[246:247], v[254:255], v[226:227], v[246:247] op_sel:[0,1,0] op_sel_hi:[1,1,1]
    v_lshlrev_b32 v248, 16, v172
    v_and_b32 v249, 0xffff0000, v172
    v_lshlrev_b32 v250, 16, v173
    v_and_b32 v251, 0xffff0000, v173
    v_lshlrev_b32 v252, 16, v174
    v_and_b32 v253, 0xffff0000, v174
    v_lshlrev_b32 v254, 16, v175
    v_and_b32 v255, 0xffff0000, v175
    v_pk_fma_f32 v[240:241], v[248:249], v[228:229], v[240:241] op_sel:[0,0,0] op_sel_hi:[1,0,1]
    v_pk_fma_f32 v[242:243], v[250:251], v[228:229], v[242:243] op_sel:[0,0,0] op_sel_hi:[1,0,1]
    v_pk_fma_f32 v[244:245], v[252:253], v[228:229], v[244:245] op_sel:[0,0,0] op_sel_hi:[1,0,1]
    v_pk_fma_f32 v[246:247], v[254:255], v[228:229], v[246:247] op_sel:[0,0,0] op_sel_hi:[1,0,1]
    v_lshlrev_b32 v248, 16, v176
    v_and_b32 v249, 0xffff0000, v176
    v_lshlrev_b32 v250, 16, v177
    v_and_b32 v251, 0xffff0000, v177
    v_lshlrev_b32 v252, 16, v178
    v_and_b32 v253, 0xffff0000, v178
    v_lshlrev_b32 v254, 16, v179
    v_and_b32 v255, 0xffff0000, v179
    v_pk_fma_f32 v[240:241], v[248:249], v[228:229], v[240:241] op_sel:[0,1,0] op_sel_hi:[1,1,1]
    v_pk_fma_f32 v[242:243], v[250:251], v[228:229], v[242:243] op_sel:[0,1,0] op_sel_hi:[1,1,1]
    v_pk_fma_f32 v[244:245], v[252:253], v[228:229], v[244:245] op_sel:[0,1,0] op_sel_hi:[1,1,1]
    v_pk_fma_f32 v[246:247], v[254:255], v[228:229], v[246:247] op_sel:[0,1,0] op_sel_hi:[1,1,1]
    v_lshlrev_b32 v248, 16, v180
    v_and_b32 v249, 0xffff0000, v180
    v_lshlrev_b32 v250, 16, v181
    v_and_b32 v251, 0xffff0000, v181
    v_lshlrev_b32 v252, 16, v182
    v_and_b32 v253, 0xffff0000, v182
    v_lshlrev_b32 v254, 16, v183
    v_and_b32 v255, 0xffff0000, v183
    v_pk_fma_f32 v[240:241], v[248:249], v[230:231], v[240:241] op_sel:[0,0,0] op_sel_hi:[1,0,1]
    v_pk_fma_f32 v[242:243], v[250:251], v[230:231], v[242:243] op_sel:[0,0,0] op_sel_hi:[1,0,1]
    v_pk_fma_f32 v[244:245], v[252:253], v[230:231], v[244:245] op_sel:[0,0,0] op_sel_hi:[1,0,1]
    v_pk_fma_f32 v[246:247], v[254:255], v[230:231], v[246:247] op_sel:[0,0,0] op_sel_hi:[1,0,1]
    v_lshlrev_b32 v248, 16, v184
    v_and_b32 v249, 0xffff0000, v184
    v_lshlrev_b32 v250, 16, v185
    v_and_b32 v251, 0xffff0000, v185
    v_lshlrev_b32 v252, 16, v186
    v_and_b32 v253, 0xffff0000, v186
    v_lshlrev_b32 v254, 16, v187
    v_and_b32 v255, 0xffff0000, v187
    v_pk_fma_f32 v[240:241], v[248:249], v[230:231], v[240:241] op_sel:[0,1,0] op_sel_hi:[1,1,1]
    v_pk_fma_f32 v[242:243], v[250:251], v[230:231], v[242:243] op_sel:[0,1,0] op_sel_hi:[1,1,1]
    v_pk_fma_f32 v[244:245], v[252:253], v[230:231], v[244:245] op_sel:[0,1,0] op_sel_hi:[1,1,1]
    v_pk_fma_f32 v[246:247], v[254:255], v[230:231], v[246:247] op_sel:[0,1,0] op_sel_hi:[1,1,1]
    v_lshlrev_b32 v248, 16, v188
    v_and_b32 v249, 0xffff0000, v188
    v_lshlrev_b32 v250, 16, v189
    v_and_b32 v251, 0xffff0000, v189
    v_lshlrev_b32 v252, 16, v190
    v_and_b32 v253, 0xffff0000, v190
    v_lshlrev_b32 v254, 16, v191
    v_and_b32 v255, 0xffff0000, v191
    v_pk_fma_f32 v[240:241], v[248:249], v[232:233], v[240:241] op_sel:[0,0,0] op_sel_hi:[1,0,1]
    v_pk_fma_f32 v[242:243], v[250:251], v[232:233], v[242:243] op_sel:[0,0,0] op_sel_hi:[1,0,1]
    v_pk_fma_f32 v[244:245], v[252:253], v[232:233], v[244:245] op_sel:[0,0,0] op_sel_hi:[1,0,1]
    v_pk_fma_f32 v[246:247], v[254:255], v[232:233], v[246:247] op_sel:[0,0,0] op_sel_hi:[1,0,1]
    v_lshlrev_b32 v248, 16, v192
    v_and_b32 v249, 0xffff0000, v192
    v_lshlrev_b32 v250, 16, v193
    v_and_b32 v251, 0xffff0000, v193
    v_lshlrev_b32 v252, 16, v194
    v_and_b32 v253, 0xffff0000, v194
    v_lshlrev_b32 v254, 16, v195
    v_and_b32 v255, 0xffff0000, v195
    v_pk_fma_f32 v[240:241], v[248:249], v[232:233], v[240:241] op_sel:[0,1,0] op_sel_hi:[1,1,1]
    v_pk_fma_f32 v[242:243], v[250:251], v[232:233], v[242:243] op_sel:[0,1,0] op_sel_hi:[1,1,1]
    v_pk_fma_f32 v[244:245], v[252:253], v[232:233], v[244:245] op_sel:[0,1,0] op_sel_hi:[1,1,1]
    v_pk_fma_f32 v[246:247], v[254:255], v[232:233], v[246:247] op_sel:[0,1,0] op_sel_hi:[1,1,1]
    v_lshlrev_b32 v248, 16, v196
    v_and_b32 v249, 0xffff0000, v196
    v_lshlrev_b32 v250, 16, v197
    v_and_b32 v251, 0xffff0000, v197
    v_lshlrev_b32 v252, 16, v198
    v_and_b32 v253, 0xffff0000, v198
    v_lshlrev_b32 v254, 16, v199
    v_and_b32 v255, 0xffff0000, v199
    v_pk_fma_f32 v[240:241], v[248:249], v[234:235], v[240:241] op_sel:[0,0,0] op_sel_hi:[1,0,1]
    v_pk_fma_f32 v[242:243], v[250:251], v[234:235], v[242:243] op_sel:[0,0,0] op_sel_hi:[1,0,1]
    v_pk_fma_f32 v[244:245], v[252:253], v[234:235], v[244:245] op_sel:[0,0,0] op_sel_hi:[1,0,1]
    v_pk_fma_f32 v[246:247], v[254:255], v[234:235], v[246:247] op_sel:[0,0,0] op_sel_hi:[1,0,1]
    v_lshlrev_b32 v248, 16, v200
    v_and_b32 v249, 0xffff0000, v200
    v_lshlrev_b32 v250, 16, v201
    v_and_b32 v251, 0xffff0000, v201
    v_lshlrev_b32 v252, 16, v202
    v_and_b32 v253, 0xffff0000, v202
    v_lshlrev_b32 v254, 16, v203
    v_and_b32 v255, 0xffff0000, v203
    v_pk_fma_f32 v[240:241], v[248:249], v[234:235], v[240:241] op_sel:[0,1,0] op_sel_hi:[1,1,1]
    v_pk_fma_f32 v[242:243], v[250:251], v[234:235], v[242:243] op_sel:[0,1,0] op_sel_hi:[1,1,1]
    v_pk_fma_f32 v[244:245], v[252:253], v[234:235], v[244:245] op_sel:[0,1,0] op_sel_hi:[1,1,1]
    v_pk_fma_f32 v[246:247], v[254:255], v[234:235], v[246:247] op_sel:[0,1,0] op_sel_hi:[1,1,1]
    v_lshlrev_b32 v248, 16, v204
    v_and_b32 v249, 0xffff0000, v204
    v_lshlrev_b32 v250, 16, v205
    v_and_b32 v251, 0xffff0000, v205
    v_lshlrev_b32 v252, 16, v206
    v_and_b32 v253, 0xffff0000, v206
    v_lshlrev_b32 v254, 16, v207
    v_and_b32 v255, 0xffff0000, v207
    v_pk_fma_f32 v[240:241], v[248:249], v[236:237], v[240:241] op_sel:[0,0,0] op_sel_hi:[1,0,1]
    v_pk_fma_f32 v[242:243], v[250:251], v[236:237], v[242:243] op_sel:[0,0,0] op_sel_hi:[1,0,1]
    v_pk_fma_f32 v[244:245], v[252:253], v[236:237], v[244:245] op_sel:[0,0,0] op_sel_hi:[1,0,1]
    v_pk_fma_f32 v[246:247], v[254:255], v[236:237], v[246:247] op_sel:[0,0,0] op_sel_hi:[1,0,1]
    v_lshlrev_b32 v248, 16, v208
    v_and_b32 v249, 0xffff0000, v208
    v_lshlrev_b32 v250, 16, v209
    v_and_b32 v251, 0xffff0000, v209
    v_lshlrev_b32 v252, 16, v210
    v_and_b32 v253, 0xffff0000, v210
    v_lshlrev_b32 v254, 16, v211
    v_and_b32 v255, 0xffff0000, v211
    v_pk_fma_f32 v[240:241], v[248:249], v[236:237], v[240:241] op_sel:[0,1,0] op_sel_hi:[1,1,1]
    v_pk_fma_f32 v[242:243], v[250:251], v[236:237], v[242:243] op_sel:[0,1,0] op_sel_hi:[1,1,1]
    v_pk_fma_f32 v[244:245], v[252:253], v[236:237], v[244:245] op_sel:[0,1,0] op_sel_hi:[1,1,1]
    v_pk_fma_f32 v[246:247], v[254:255], v[236:237], v[246:247] op_sel:[0,1,0] op_sel_hi:[1,1,1]
    v_lshlrev_b32 v248, 16, v212
    v_and_b32 v249, 0xffff0000, v212
    v_lshlrev_b32 v250, 16, v213
    v_and_b32 v251, 0xffff0000, v213
    v_lshlrev_b32 v252, 16, v214
    v_and_b32 v253, 0xffff0000, v214
    v_lshlrev_b32 v254, 16, v215
    v_and_b32 v255, 0xffff0000, v215
    v_pk_fma_f32 v[240:241], v[248:249], v[238:239], v[240:241] op_sel:[0,0,0] op_sel_hi:[1,0,1]
    v_pk_fma_f32 v[242:243], v[250:251], v[238:239], v[242:243] op_sel:[0,0,0] op_sel_hi:[1,0,1]
    v_pk_fma_f32 v[244:245], v[252:253], v[238:239], v[244:245] op_sel:[0,0,0] op_sel_hi:[1,0,1]
    v_pk_fma_f32 v[246:247], v[254:255], v[238:239], v[246:247] op_sel:[0,0,0] op_sel_hi:[1,0,1]
    v_lshlrev_b32 v248, 16, v216
    v_and_b32 v249, 0xffff0000, v216
    v_lshlrev_b32 v250, 16, v217
    v_and_b32 v251, 0xffff0000, v217
    v_lshlrev_b32 v252, 16, v218
    v_and_b32 v253, 0xffff0000, v218
    v_lshlrev_b32 v254, 16, v219
    v_and_b32 v255, 0xffff0000, v219
    v_pk_fma_f32 v[240:241], v[248:249], v[238:239], v[240:241] op_sel:[0,1,0] op_sel_hi:[1,1,1]
    v_pk_fma_f32 v[242:243], v[250:251], v[238:239], v[242:243] op_sel:[0,1,0] op_sel_hi:[1,1,1]
    v_pk_fma_f32 v[244:245], v[252:253], v[238:239], v[244:245] op_sel:[0,1,0] op_sel_hi:[1,1,1]
    v_pk_fma_f32 v[246:247], v[254:255], v[238:239], v[246:247] op_sel:[0,1,0] op_sel_hi:[1,1,1]
    s_nop 0
    v_permlane32_swap_b32 v240, v244
    v_permlane32_swap_b32 v241, v245
    v_permlane32_swap_b32 v242, v246
    v_permlane32_swap_b32 v243, v247
    v_pk_add_f32 v[240:241], v[240:241], v[244:245]
    v_pk_add_f32 v[242:243], v[242:243], v[246:247]
    v_and_b32 v4, 7, v1
    v_lshlrev_b32 v4, 5, v4
    v_permlane16_swap_b32 v240, v242
    v_permlane16_swap_b32 v241, v243
    v_pk_add_f32 v[240:241], v[240:241], v[242:243]
    v_lshrrev_b32 v5, 4, v1
    v_lshl_add_u32 v4, v5, 3, v4
    v_add_f32_dpp v240, v240, v240 row_ror:8 row_mask:0xf bank_mask:0xf
    v_add_f32_dpp v241, v241, v241 row_ror:8 row_mask:0xf bank_mask:0xf
    s_lshl_b32 s88, s88, 8
    s_add_u32 s88, s88, 1441792
    s_cmp_lt_u32 s2, 240
    s_cselect_b32 s88, s88, 2147483648
    s_mov_b32 exec_lo, 0x00ff00ff
    s_mov_b32 exec_hi, 0x00ff00ff
    buffer_store_dwordx2 v[240:241], v4, s[56:59], s88 offen sc1
    s_mov_b64 exec, -1
L_nopart:
    s_cmp_eq_u32 s9, 0
    s_cbranch_scc1 L_nonconv
    s_cmp_eq_u32 s3, 4
    s_cbranch_scc1 L_conv_w4
    s_mul_i32 s10, s3, 16656
    v_lshlrev_b32 v2, 4, v1
    v_add_u32 v3, 48, v2
    v_add_u32 v3, s10, v3
    v_lshrrev_b32 v6, 2, v1
    v_mul_u32_u24 v7, 260, v6
    v_min_u32 v6, 1, v6
    v_and_b32 v8, 3, v1
    v_add3_u32 v6, v6, v7, v8
    v_lshlrev_b32 v6, 4, v6
    v_add_u32 v6, s10, v6
    v_mov_b32 v8, 0
    v_mov_b32 v9, 0
    v_mov_b32 v10, 0
    v_mov_b32 v11, 0
    s_mov_b64 exec, 0xffff
    ds_write_b128 v6, v[8:11]
    s_mov_b64 exec, -1
    v_and_b32 v4, 15, v1
    v_lshrrev_b32 v5, 4, v1
    v_add_u32 v6, 1, v4
    v_and_b32 v7, 3, v6
    v_lshrrev_b32 v6, 2, v6
    v_add_u32 v6, v6, v5
    v_mul_u32_u24 v12, 260, v7
    v_min_u32 v7, 1, v7
    v_add3_u32 v6, v6, v12, v7
    v_lshlrev_b32 v6, 4, v6
    v_add_u32 v222, s10, v6
    s_mul_i32 s11, s3, 9120
    s_add_u32 s11, s11, 66624
    v_add_u32 v224, s11, v2
    v_lshrrev_b32 v6, 1, v4
    v_lshlrev_b32 v6, 2, v6
    v_sub_u32 v6, v5, v6
    v_add_u32 v6, 28, v6
    v_and_b32 v7, 1, v4
    v_xor_b32 v7, 1, v7
    v_mul_u32_u24 v7, 286, v7
    v_add_u32 v6, v6, v7
    v_lshlrev_b32 v6, 4, v6
    v_add_u32 v223, s11, v6
    s_mov_b64 exec, 0xfffffff
    ds_write_b128 v224, v[8:11] offset:4096
    ds_write_b128 v224, v[8:11] offset:8672
    s_mov_b64 exec, -1
    s_lshr_b32 s10, s3, 1
    s_cmp_eq_u32 s10, 0
    s_cselect_b32 s10, s80, s81
    s_and_b32 s11, s3, 1
    s_lshl_b32 s11, s11, 4
    s_lshr_b32 s10, s10, s11
    s_and_b32 s10, s10, 0xffff
    v_mov_b32 v7, s10
    v_lshlrev_b32 v6, 2, v5
    v_add_u32 v6, v6, v4
    v_sub_u32 v6, 15, v6
    v_cmp_eq_u32 vcc, 0, v6
    s_nop 1
    v_cndmask_b32 v12, 0, v7, vcc
    v_cmp_eq_u32 vcc, 1, v6
    s_nop 1
    v_cndmask_b32 v13, 0, v7, vcc
    v_cmp_eq_u32 vcc, 2, v6
    s_nop 1
    v_cndmask_b32 v14, 0, v7, vcc
    v_cmp_eq_u32 vcc, 3, v6
    s_nop 1
    v_cndmask_b32 v15, 0, v7, vcc
    v_lshlrev_b32 v151, 5, v133
    v_add_u32 v151, 161216, v151
    v_lshrrev_b32 v150, 5, v1
    v_lshlrev_b32 v150, 2, v150
    s_lshl_b32 s10, s3, 3
    v_add3_u32 v150, v150, s10, v151
    v_lshrrev_b32 v6, 2, v4
    v_lshl_add_u32 v6, v5, 3, v6
    v_lshlrev_b32 v6, 2, v6
    v_add_u32 v6, s3, v6
    v_lshrrev_b32 v7, 3, v4
    v_and_b32 v8, 1, v5
    v_lshl_add_u32 v7, v8, 1, v7
    v_xor_b32 v6, v6, v7
    v_lshlrev_b32 v6, 4, v6
    v_and_b32 v7, 3, v4
    v_lshl_add_u32 v6, v7, 2, v6
    v_add_u32 v227, 103104, v6
    s_lshl_b32 s10, s7, 2
    s_add_u32 s10, s10, s3
    s_lshl_b32 s10, s10, 12
    s_add_u32 s10, s10, 2097152
    v_add_u32 v2, s10, v2
    v_lshrrev_b32 v6, 3, v0
    v_and_b32 v6, 1, v6
    v_lshrrev_b32 v7, 4, v0
    v_and_b32 v7, 2, v7
    v_or_b32 v6, v6, v7
    v_xor_b32 v6, v6, v0
    v_lshlrev_b32 v6, 4, v6
    v_add_u32 v6, 113344, v6
    v_lshrrev_b32 v7, 2, v0
    v_mul_u32_u24 v7, 10240, v7
    v_and_b32 v8, 3, v0
    v_lshl_add_u32 v7, v8, 4, v7
    s_lshl_b32 s10, s7, 6
    s_add_u32 s10, s10, 6881280
    v_add_u32 v7, s10, v7
    v_mov_b32 v128, v6
    v_mov_b32 v129, v7
    v_mov_b32 v134, 162776
    v_mov_b32 v130, 1
    v_mov_b32 v64, 0
    v_mov_b32 v32, 0
    v_mov_b32 v33, 0
    ds_write_b128 v3, v[34:37] offset:16
    v_mov_b32_dpp v64, v35 wave_shr:1 row_mask:0xf bank_mask:0xf
    v_mov_b32_dpp v32, v36 wave_shr:1 row_mask:0xf bank_mask:0xf
    v_mov_b32_dpp v33, v37 wave_shr:1 row_mask:0xf bank_mask:0xf
    v_mov_b32 v67, v34
    v_mov_b32 v68, v35
    v_mov_b32 v69, v36
    ds_write_b128 v3, v[32:35] offset:8336
    v_mov_b32 v65, v32
    v_mov_b32 v66, v33
    ds_write_b128 v3, v[64:67] offset:4176
    ds_write_b128 v3, v[66:69] offset:12496
    v_mov_b32_dpp v72, v35 wave_ror:1 row_mask:0xf bank_mask:0xf
    v_mov_b32_dpp v40, v36 wave_ror:1 row_mask:0xf bank_mask:0xf
    v_mov_b32_dpp v41, v37 wave_ror:1 row_mask:0xf bank_mask:0xf
    ds_write_b128 v3, v[42:45] offset:1040
    v_mov_b32_dpp v72, v43 wave_shr:1 row_mask:0xf bank_mask:0xf
    v_mov_b32_dpp v40, v44 wave_shr:1 row_mask:0xf bank_mask:0xf
    v_mov_b32_dpp v41, v45 wave_shr:1 row_mask:0xf bank_mask:0xf
    v_mov_b32 v75, v42
    v_mov_b32 v76, v43
    v_mov_b32 v77, v44
    ds_write_b128 v3, v[40:43] offset:9360
    v_mov_b32 v73, v40
    v_mov_b32 v74, v41
    ds_write_b128 v3, v[72:75] offset:5200
    ds_write_b128 v3, v[74:77] offset:13520
    v_mov_b32_dpp v64, v43 wave_ror:1 row_mask:0xf bank_mask:0xf
    v_mov_b32_dpp v48, v44 wave_ror:1 row_mask:0xf bank_mask:0xf
    v_mov_b32_dpp v49, v45 wave_ror:1 row_mask:0xf bank_mask:0xf
    ds_write_b128 v3, v[50:53] offset:2064
    v_mov_b32_dpp v64, v51 wave_shr:1 row_mask:0xf bank_mask:0xf
    v_mov_b32_dpp v48, v52 wave_shr:1 row_mask:0xf bank_mask:0xf
    v_mov_b32_dpp v49, v53 wave_shr:1 row_mask:0xf bank_mask:0xf
    v_mov_b32 v67, v50
    v_mov_b32 v68, v51
    v_mov_b32 v69, v52
    ds_write_b128 v3, v[48:51] offset:10384
    v_mov_b32 v65, v48
    v_mov_b32 v66, v49
    ds_write_b128 v3, v[64:67] offset:6224
    ds_write_b128 v3, v[66:69] offset:14544
    v_mov_b32_dpp v72, v51 wave_ror:1 row_mask:0xf bank_mask:0xf
    v_mov_b32_dpp v56, v52 wave_ror:1 row_mask:0xf bank_mask:0xf
    v_mov_b32_dpp v57, v53 wave_ror:1 row_mask:0xf bank_mask:0xf
    ds_write_b128 v3, v[58:61] offset:3088
    v_mov_b32_dpp v72, v59 wave_shr:1 row_mask:0xf bank_mask:0xf
    v_mov_b32_dpp v56, v60 wave_shr:1 row_mask:0xf bank_mask:0xf
    v_mov_b32_dpp v57, v61 wave_shr:1 row_mask:0xf bank_mask:0xf
    v_mov_b32 v75, v58
    v_mov_b32 v76, v59
    v_mov_b32 v77, v60
    ds_write_b128 v3, v[56:59] offset:11408
    v_mov_b32 v73, v56
    v_mov_b32 v74, v57
    ds_write_b128 v3, v[72:75] offset:7248
    ds_write_b128 v3, v[74:77] offset:15568
    s_waitcnt lgkmcnt(0)
    ds_read_b128 v[48:51], v222 offset:0
    ds_read_b128 v[52:55], v222 offset:512
    ds_read_b128 v[56:59], v222 offset:1024
    ds_read_b128 v[60:63], v222 offset:1536
    ds_read_b128 v[64:67], v222 offset:2048
    s_barrier
    buffer_load_dwordx4 v[228:231], v2, s[56:59], 0 offen offset:0 sc1
    buffer_load_dwordx4 v[232:235], v2, s[56:59], 0 offen offset:1024 sc1
    buffer_load_dwordx4 v[236:239], v2, s[56:59], 0 offen offset:2048 sc1
    buffer_load_dwordx4 v[240:243], v2, s[56:59], 0 offen offset:3072 sc1
    s_waitcnt vmcnt(3)
    ds_write_b128 v224, v[228:231] offset:0
    s_waitcnt vmcnt(2)
    ds_write_b128 v224, v[232:235] offset:1024
    v_mov_b32_dpp v244, v232 wave_rol:1 row_mask:0xf bank_mask:0xf
    v_alignbit_b32 v112, v229, v228, 16
    v_alignbit_b32 v113, v230, v229, 16
    v_alignbit_b32 v114, v231, v230, 16
    v_mov_b32_dpp v244, v228 wave_shl:1 row_mask:0xf bank_mask:0xf
    v_alignbit_b32 v115, v244, v231, 16
    ds_write_b128 v224, v[112:115] offset:4576
    s_waitcnt vmcnt(1)
    ds_write_b128 v224, v[236:239] offset:2048
    v_mov_b32_dpp v245, v236 wave_rol:1 row_mask:0xf bank_mask:0xf
    v_alignbit_b32 v116, v233, v232, 16
    v_alignbit_b32 v117, v234, v233, 16
    v_alignbit_b32 v118, v235, v234, 16
    v_mov_b32_dpp v245, v232 wave_shl:1 row_mask:0xf bank_mask:0xf
    v_alignbit_b32 v119, v245, v235, 16
    ds_write_b128 v224, v[116:119] offset:5600
    s_waitcnt vmcnt(0)
    ds_write_b128 v224, v[240:243] offset:3072
    v_mov_b32_dpp v244, v240 wave_rol:1 row_mask:0xf bank_mask:0xf
    v_alignbit_b32 v120, v237, v236, 16
    v_alignbit_b32 v121, v238, v237, 16
    v_alignbit_b32 v122, v239, v238, 16
    v_mov_b32_dpp v244, v236 wave_shl:1 row_mask:0xf bank_mask:0xf
    v_alignbit_b32 v123, v244, v239, 16
    ds_write_b128 v224, v[120:123] offset:6624
    v_mov_b32 v245, 0
    v_alignbit_b32 v124, v241, v240, 16
    v_alignbit_b32 v125, v242, v241, 16
    v_alignbit_b32 v126, v243, v242, 16
    v_mov_b32_dpp v245, v240 wave_shl:1 row_mask:0xf bank_mask:0xf
    v_alignbit_b32 v127, v245, v243, 16
    ds_write_b128 v224, v[124:127] offset:7648
    ds_read_b128 v[80:83], v223 offset:3584
    ds_read_b128 v[84:87], v223 offset:3072
    ds_read_b128 v[88:91], v223 offset:2560
    ds_read_b128 v[92:95], v223 offset:2048
    ds_read_b128 v[96:99], v223 offset:1536
    s_waitcnt lgkmcnt(4)
    v_mfma_f32_16x16x32_bf16 v[112:115], v[80:83], v[12:15], 0
    s_waitcnt lgkmcnt(3)
    v_mfma_f32_16x16x32_bf16 v[116:119], v[84:87], v[12:15], 0
    s_waitcnt lgkmcnt(2)
    v_mfma_f32_16x16x32_bf16 v[120:123], v[88:91], v[12:15], 0
    s_waitcnt lgkmcnt(1)
    v_mfma_f32_16x16x32_bf16 v[124:127], v[92:95], v[12:15], 0
    s_waitcnt lgkmcnt(0)
    v_mfma_f32_16x16x32_bf16 v[36:39], v[96:99], v[12:15], 0
    s_mov_b32 s14, 0
    s_movk_i32 s11, 128
L_g1:
    s_waitcnt lgkmcnt(0)
    v_mfma_f32_16x16x32_bf16 v[112:115], v[80:83], v[48:51], v[112:115]
    ds_read_b128 v[16:19], v222 offset:64
    v_mfma_f32_16x16x32_bf16 v[116:119], v[84:87], v[48:51], v[116:119]
    ds_read_b128 v[228:231], v223 offset:3648
    v_mfma_f32_16x16x32_bf16 v[120:123], v[88:91], v[48:51], v[120:123]
    ds_read_b128 v[20:23], v222 offset:576
    v_mfma_f32_16x16x32_bf16 v[124:127], v[92:95], v[48:51], v[124:127]
    ds_read_b128 v[232:235], v223 offset:3136
    v_mfma_f32_16x16x32_bf16 v[36:39], v[96:99], v[48:51], v[36:39]
    ds_read_b128 v[24:27], v222 offset:1088
    v_mfma_f32_16x16x32_bf16 v[116:119], v[80:83], v[52:55], v[116:119]
    ds_read_b128 v[236:239], v223 offset:2624
    v_mfma_f32_16x16x32_bf16 v[120:123], v[84:87], v[52:55], v[120:123]
    ds_read_b128 v[28:31], v222 offset:1600
    v_mfma_f32_16x16x32_bf16 v[124:127], v[88:91], v[52:55], v[124:127]
    ds_read_b128 v[240:243], v223 offset:2112
    v_mfma_f32_16x16x32_bf16 v[36:39], v[92:95], v[52:55], v[36:39]
    ds_read_b128 v[32:35], v222 offset:2112
    v_mfma_f32_16x16x32_bf16 v[120:123], v[80:83], v[56:59], v[120:123]
    ds_read_b128 v[244:247], v223 offset:1600
    v_mfma_f32_16x16x32_bf16 v[124:127], v[84:87], v[56:59], v[124:127]
    s_cmp_eq_u32 s14, 3
    v_mfma_f32_16x16x32_bf16 v[36:39], v[88:91], v[56:59], v[36:39]
    s_cselect_b32 s10, -384, s11
    v_mfma_f32_16x16x32_bf16 v[124:127], v[80:83], v[60:63], v[124:127]
    v_add_u32 v222, s10, v222
    v_mfma_f32_16x16x32_bf16 v[36:39], v[84:87], v[60:63], v[36:39]
    v_add_u32 v223, s10, v223
    v_mfma_f32_16x16x32_bf16 v[36:39], v[80:83], v[64:67], v[36:39]
    s_waitcnt lgkmcnt(0)
    v_mfma_f32_16x16x32_bf16 v[112:115], v[228:231], v[16:19], v[112:115]
    ds_read_b128 v[48:51], v222 offset:0
    v_mfma_f32_16x16x32_bf16 v[116:119], v[232:235], v[16:19], v[116:119]
    ds_read_b128 v[80:83], v223 offset:3584
    v_mfma_f32_16x16x32_bf16 v[120:123], v[236:239], v[16:19], v[120:123]
    ds_read_b128 v[52:55], v222 offset:512
    v_mfma_f32_16x16x32_bf16 v[124:127], v[240:243], v[16:19], v[124:127]
    ds_read_b128 v[84:87], v223 offset:3072
    v_mfma_f32_16x16x32_bf16 v[36:39], v[244:247], v[16:19], v[36:39]
    ds_read_b128 v[56:59], v222 offset:1024
    v_mfma_f32_16x16x32_bf16 v[116:119], v[228:231], v[20:23], v[116:119]
    ds_read_b128 v[88:91], v223 offset:2560
    v_mfma_f32_16x16x32_bf16 v[120:123], v[232:235], v[20:23], v[120:123]
    ds_read_b128 v[60:63], v222 offset:1536
    v_mfma_f32_16x16x32_bf16 v[124:127], v[236:239], v[20:23], v[124:127]
    ds_read_b128 v[92:95], v223 offset:2048
    v_mfma_f32_16x16x32_bf16 v[36:39], v[240:243], v[20:23], v[36:39]
    ds_read_b128 v[64:67], v222 offset:2048
    v_mfma_f32_16x16x32_bf16 v[120:123], v[228:231], v[24:27], v[120:123]
    ds_read_b128 v[96:99], v223 offset:1536
    v_mfma_f32_16x16x32_bf16 v[124:127], v[232:235], v[24:27], v[124:127]
    s_add_u32 s14, s14, 1
    v_mfma_f32_16x16x32_bf16 v[36:39], v[236:239], v[24:27], v[36:39]
    s_cmp_lt_u32 s14, 4
    v_mfma_f32_16x16x32_bf16 v[124:127], v[228:231], v[28:31], v[124:127]
    v_mfma_f32_16x16x32_bf16 v[36:39], v[232:235], v[28:31], v[36:39]
    v_mfma_f32_16x16x32_bf16 v[36:39], v[228:231], v[32:35], v[36:39]
    s_cbranch_scc1 L_g1
    ds_read_b128 v[100:103], v223 offset:1024
    ds_read_b128 v[104:107], v223 offset:512
    ds_read_b128 v[108:111], v223 offset:0
    ds_read_b128 v[68:71], v222 offset:2560
    ds_read_b128 v[72:75], v222 offset:3072
    ds_read_b128 v[76:79], v222 offset:3584
    v_mov_b32 v26, 162772
    v_mov_b32 v27, 1
    v_cvt_pk_bf16_f32 v16, v112, v113
    v_cvt_pk_bf16_f32 v17, v114, v115
    ds_write2st64_b32 v227, v16, v17 offset0:0 offset1:1
    v_cvt_pk_bf16_f32 v18, v116, v117
    v_cvt_pk_bf16_f32 v19, v118, v119
    ds_write2st64_b32 v227, v18, v19 offset0:8 offset1:9
    v_cvt_pk_bf16_f32 v20, v120, v121
    v_cvt_pk_bf16_f32 v21, v122, v123
    ds_write2st64_b32 v227, v20, v21 offset0:16 offset1:17
    v_cvt_pk_bf16_f32 v22, v124, v125
    v_cvt_pk_bf16_f32 v23, v126, v127
    ds_write2st64_b32 v227, v22, v23 offset0:24 offset1:25
    v_cvt_pk_bf16_f32 v24, v36, v37
    v_cvt_pk_bf16_f32 v25, v38, v39
    ds_write2st64_b32 v227, v24, v25 offset0:32 offset1:33
    s_mov_b64 exec, 1
    ds_add_u32 v26, v27
    s_mov_b64 exec, -1
    s_waitcnt lgkmcnt(6)
    v_mfma_f32_16x16x32_bf16 v[40:43], v[100:103], v[12:15], 0
    v_mfma_f32_16x16x32_bf16 v[44:47], v[104:107], v[12:15], 0
    v_mfma_f32_16x16x32_bf16 v[248:251], v[108:111], v[12:15], 0
    s_mov_b32 s14, 0
L_g2:
    s_waitcnt lgkmcnt(7)
    v_mfma_f32_16x16x32_bf16 v[248:251], v[108:111], v[48:51], v[248:251]
    ds_read_b128 v[108:111], v223 offset:64
    v_mfma_f32_16x16x32_bf16 v[44:47], v[104:107], v[48:51], v[44:47]
    ds_read_b128 v[76:79], v222 offset:3584
    v_mfma_f32_16x16x32_bf16 v[40:43], v[100:103], v[48:51], v[40:43]
    s_add_u32 s14, s14, 2
    v_mfma_f32_16x16x32_bf16 v[248:251], v[104:107], v[52:55], v[248:251]
    ds_read_b128 v[104:107], v223 offset:576
    v_mfma_f32_16x16x32_bf16 v[44:47], v[100:103], v[52:55], v[44:47]
    ds_read_b128 v[48:51], v222 offset:64
    v_mfma_f32_16x16x32_bf16 v[40:43], v[96:99], v[52:55], v[40:43]
    s_cmp_lt_u32 s14, 8
    v_mfma_f32_16x16x32_bf16 v[248:251], v[100:103], v[56:59], v[248:251]
    ds_read_b128 v[100:103], v223 offset:1088
    v_mfma_f32_16x16x32_bf16 v[44:47], v[96:99], v[56:59], v[44:47]
    ds_read_b128 v[52:55], v222 offset:576
    v_mfma_f32_16x16x32_bf16 v[40:43], v[92:95], v[56:59], v[40:43]
    s_waitcnt lgkmcnt(4)
    v_mfma_f32_16x16x32_bf16 v[248:251], v[96:99], v[60:63], v[248:251]
    ds_read_b128 v[96:99], v223 offset:1600
    v_mfma_f32_16x16x32_bf16 v[44:47], v[92:95], v[60:63], v[44:47]
    ds_read_b128 v[56:59], v222 offset:1088
    v_mfma_f32_16x16x32_bf16 v[40:43], v[88:91], v[60:63], v[40:43]
    v_mfma_f32_16x16x32_bf16 v[248:251], v[92:95], v[64:67], v[248:251]
    ds_read_b128 v[92:95], v223 offset:2112
    v_mfma_f32_16x16x32_bf16 v[44:47], v[88:91], v[64:67], v[44:47]
    ds_read_b128 v[60:63], v222 offset:1600
    v_mfma_f32_16x16x32_bf16 v[40:43], v[84:87], v[64:67], v[40:43]
    v_mfma_f32_16x16x32_bf16 v[248:251], v[88:91], v[68:71], v[248:251]
    ds_read_b128 v[88:91], v223 offset:2624
    v_mfma_f32_16x16x32_bf16 v[44:47], v[84:87], v[68:71], v[44:47]
    ds_read_b128 v[64:67], v222 offset:2112
    v_mfma_f32_16x16x32_bf16 v[40:43], v[80:83], v[68:71], v[40:43]
    v_mfma_f32_16x16x32_bf16 v[248:251], v[84:87], v[72:75], v[248:251]
    ds_read_b128 v[84:87], v223 offset:3136
    v_mfma_f32_16x16x32_bf16 v[44:47], v[80:83], v[72:75], v[44:47]
    ds_read_b128 v[68:71], v222 offset:2624
    v_mfma_f32_16x16x32_bf16 v[248:251], v[80:83], v[76:79], v[248:251]
    ds_read_b128 v[80:83], v223 offset:3648
    ds_read_b128 v[72:75], v222 offset:3136
    s_waitcnt lgkmcnt(7)
    v_mfma_f32_16x16x32_bf16 v[248:251], v[108:111], v[48:51], v[248:251]
    ds_read_b128 v[108:111], v223 offset:128
    v_mfma_f32_16x16x32_bf16 v[44:47], v[104:107], v[48:51], v[44:47]
    ds_read_b128 v[76:79], v222 offset:3648
    v_mfma_f32_16x16x32_bf16 v[40:43], v[100:103], v[48:51], v[40:43]
    v_mfma_f32_16x16x32_bf16 v[248:251], v[104:107], v[52:55], v[248:251]
    ds_read_b128 v[104:107], v223 offset:640
    v_mfma_f32_16x16x32_bf16 v[44:47], v[100:103], v[52:55], v[44:47]
    ds_read_b128 v[48:51], v222 offset:128
    v_mfma_f32_16x16x32_bf16 v[40:43], v[96:99], v[52:55], v[40:43]
    v_mfma_f32_16x16x32_bf16 v[248:251], v[100:103], v[56:59], v[248:251]
    ds_read_b128 v[100:103], v223 offset:1152
    v_mfma_f32_16x16x32_bf16 v[44:47], v[96:99], v[56:59], v[44:47]
    ds_read_b128 v[52:55], v222 offset:640
    v_mfma_f32_16x16x32_bf16 v[40:43], v[92:95], v[56:59], v[40:43]
    s_waitcnt lgkmcnt(4)
    v_mfma_f32_16x16x32_bf16 v[248:251], v[96:99], v[60:63], v[248:251]
    ds_read_b128 v[96:99], v223 offset:1664
    v_mfma_f32_16x16x32_bf16 v[44:47], v[92:95], v[60:63], v[44:47]
    ds_read_b128 v[56:59], v222 offset:1152
    v_mfma_f32_16x16x32_bf16 v[40:43], v[88:91], v[60:63], v[40:43]
    v_mfma_f32_16x16x32_bf16 v[248:251], v[92:95], v[64:67], v[248:251]
    ds_read_b128 v[92:95], v223 offset:2176
    v_mfma_f32_16x16x32_bf16 v[44:47], v[88:91], v[64:67], v[44:47]
    ds_read_b128 v[60:63], v222 offset:1664
    v_mfma_f32_16x16x32_bf16 v[40:43], v[84:87], v[64:67], v[40:43]
    v_mfma_f32_16x16x32_bf16 v[248:251], v[88:91], v[68:71], v[248:251]
    ds_read_b128 v[88:91], v223 offset:2688
    v_mfma_f32_16x16x32_bf16 v[44:47], v[84:87], v[68:71], v[44:47]
    ds_read_b128 v[64:67], v222 offset:2176
    v_mfma_f32_16x16x32_bf16 v[40:43], v[80:83], v[68:71], v[40:43]
    v_mfma_f32_16x16x32_bf16 v[248:251], v[84:87], v[72:75], v[248:251]
    ds_read_b128 v[84:87], v223 offset:3200
    v_mfma_f32_16x16x32_bf16 v[44:47], v[80:83], v[72:75], v[44:47]
    ds_read_b128 v[68:71], v222 offset:2688
    v_mfma_f32_16x16x32_bf16 v[248:251], v[80:83], v[76:79], v[248:251]
    ds_read_b128 v[80:83], v223 offset:3712
    ds_read_b128 v[72:75], v222 offset:3200
    v_add_u32 v222, 128, v222
    v_add_u32 v223, 128, v223
    s_cbranch_scc1 L_g2
    v_cvt_pk_bf16_f32 v16, v40, v41
    v_cvt_pk_bf16_f32 v17, v42, v43
    ds_write2st64_b32 v227, v16, v17 offset0:40 offset1:41
    v_cvt_pk_bf16_f32 v18, v44, v45
    v_cvt_pk_bf16_f32 v19, v46, v47
    ds_write2st64_b32 v227, v18, v19 offset0:48 offset1:49
    v_cvt_pk_bf16_f32 v20, v248, v249
    v_cvt_pk_bf16_f32 v21, v250, v251
    ds_write2st64_b32 v227, v20, v21 offset0:56 offset1:57
    s_mov_b64 exec, 1
    ds_add_rtn_u32 v24, v134, v130
    s_mov_b64 exec, -1
    s_mov_b32 s11, 655360
    s_mov_b32 s15, 0
    s_waitcnt lgkmcnt(0)
    v_readfirstlane_b32 s10, v24
    s_cmp_ge_u32 s10, 4
    s_cbranch_scc1 L_y0
L_yw:
    ds_read_b32 v24, v134
    s_add_u32 s15, s15, 1
    s_waitcnt lgkmcnt(0)
    v_readfirstlane_b32 s10, v24
    s_cmp_ge_u32 s10, 5
    s_cbranch_scc1 L_y0
    s_cmp_lt_u32 s15, 1600000
    s_cbranch_scc1 L_yw
L_y0:
    ds_read_b128 v[16:19], v128
    ds_read_b128 v[20:23], v128 offset:4096
    s_cmp_ge_u32 s3, 2
    s_waitcnt lgkmcnt(1)
    buffer_store_dwordx4 v[16:19], v129, s[56:59], 0 offen sc1
    s_cbranch_scc1 L_y2
    s_waitcnt lgkmcnt(0)
    buffer_store_dwordx4 v[20:23], v129, s[56:59], s11 offen sc1
L_y2:
    v_mul_u32_u24 v2, 1280, v133
    v_add_u32 v2, v2, v132
    v_add_u32 v2, 119488, v2
    v_mov_b32 v24, 162780
    s_mov_b32 s15, 0
L_lw_1:
    ds_read_b32 v25, v24
    s_waitcnt lgkmcnt(0)
    v_cmp_gt_u32 vcc, 1, v25
    s_cbranch_vccz L_lwd_2
    s_sleep 1
    s_add_u32 s15, s15, 1
    s_cmp_lt_u32 s15, 1600000
    s_cbranch_scc1 L_lw_1
L_lwd_2:
    ds_read_b64 v[140:141], v2 offset:0
    ds_read_b64 v[142:143], v2 offset:64
    ds_read_b64 v[144:145], v2 offset:128
    ds_read_b64 v[146:147], v2 offset:192
    ds_read_b64 v[148:149], v2 offset:256
    s_waitcnt lgkmcnt(0)
    v_lshlrev_b32 v64, 16, v140
    v_and_b32 v65, 0xffff0000, v140
    v_lshlrev_b32 v66, 16, v141
    v_and_b32 v67, 0xffff0000, v141
    v_lshlrev_b32 v68, 16, v142
    v_and_b32 v69, 0xffff0000, v142
    v_lshlrev_b32 v70, 16, v143
    v_and_b32 v71, 0xffff0000, v143
    v_lshlrev_b32 v72, 16, v144
    v_and_b32 v73, 0xffff0000, v144
    v_lshlrev_b32 v74, 16, v145
    v_and_b32 v75, 0xffff0000, v145
    v_lshlrev_b32 v76, 16, v146
    v_and_b32 v77, 0xffff0000, v146
    v_lshlrev_b32 v78, 16, v147
    v_and_b32 v79, 0xffff0000, v147
    v_lshlrev_b32 v80, 16, v148
    v_and_b32 v81, 0xffff0000, v148
    v_lshlrev_b32 v82, 16, v149
    v_and_b32 v83, 0xffff0000, v149
    v_pk_add_f32 v[84:85], v[64:65], v[66:67]
    v_pk_mul_f32 v[86:87], v[64:65], v[64:65]
    v_pk_fma_f32 v[86:87], v[66:67], v[66:67], v[86:87]
    v_pk_add_f32 v[84:85], v[84:85], v[68:69]
    v_pk_fma_f32 v[86:87], v[68:69], v[68:69], v[86:87]
    v_pk_add_f32 v[84:85], v[84:85], v[70:71]
    v_pk_fma_f32 v[86:87], v[70:71], v[70:71], v[86:87]
    v_pk_add_f32 v[84:85], v[84:85], v[72:73]
    v_pk_fma_f32 v[86:87], v[72:73], v[72:73], v[86:87]
    v_pk_add_f32 v[84:85], v[84:85], v[74:75]
    v_pk_fma_f32 v[86:87], v[74:75], v[74:75], v[86:87]
    v_pk_add_f32 v[84:85], v[84:85], v[76:77]
    v_pk_fma_f32 v[86:87], v[76:77], v[76:77], v[86:87]
    v_pk_add_f32 v[84:85], v[84:85], v[78:79]
    v_pk_fma_f32 v[86:87], v[78:79], v[78:79], v[86:87]
    v_pk_add_f32 v[84:85], v[84:85], v[80:81]
    v_pk_fma_f32 v[86:87], v[80:81], v[80:81], v[86:87]
    v_pk_add_f32 v[84:85], v[84:85], v[82:83]
    v_pk_fma_f32 v[86:87], v[82:83], v[82:83], v[86:87]
    v_add_f32 v84, v84, v85
    v_add_f32 v86, v86, v87
    s_nop 1
    v_permlane32_swap_b32 v84, v86
    v_add_f32 v84, v84, v86
    v_mov_b32 v86, v84
    s_nop 1
    v_permlane16_swap_b32 v84, v86
    v_add_f32 v84, v84, v86
    s_nop 1
    v_add_f32_dpp v84, v84, v84 row_ror:8 row_mask:0xf bank_mask:0xf
    ds_write_b32 v150, v84 offset:0
    s_waitcnt lgkmcnt(0)
    s_barrier
    s_branch L_row
L_conv_w4:
    s_mul_i32 s10, s7, 3277
    s_lshr_b32 s10, s10, 16
    s_lshl_b32 s10, s10, 11
    s_add_u32 s10, s10, 4096
    v_and_b32 v2, 31, v1
    v_lshlrev_b32 v2, 6, v2
    v_add_u32 v2, s10, v2
    s_mov_b32 s15, 0
L_poll_3:
    buffer_load_dword v3, v2, s[56:59], 0 offen sc1
    s_waitcnt vmcnt(0)
    v_cmp_ne_u32 vcc, s4, v3
    s_cbranch_vccz L_done_4
    s_sleep 1
    s_add_u32 s15, s15, 1
    s_cmp_lt_u32 s15, 200000
    s_cbranch_scc1 L_poll_3
L_done_4:
    s_barrier
    s_sleep 16
    v_lshlrev_b32 v2, 6, v1
    v_add_u32 v2, 4096, v2
    s_movk_i32 s10, 4096
    s_movk_i32 s11, 8192
    s_movk_i32 s12, 12288
    s_mov_b32 s15, 0
L_poll_5:
    buffer_load_dword v3, v2, s[56:59], 0 offen sc1
    buffer_load_dword v4, v2, s[56:59], s10 offen sc1
    buffer_load_dword v5, v2, s[56:59], s11 offen sc1
    buffer_load_dword v6, v2, s[56:59], s12 offen sc1
    s_waitcnt vmcnt(0)
    v_xor_b32 v3, s4, v3
    v_xor_b32 v4, s4, v4
    v_xor_b32 v5, s4, v5
    v_xor_b32 v6, s4, v6
    v_or3_b32 v3, v3, v4, v5
    v_or_b32 v3, v3, v6
    v_cmp_ne_u32 vcc, 0, v3
    s_cbranch_vccz L_done_6
    s_sleep 8
    s_add_u32 s15, s15, 1
    s_cmp_lt_u32 s15, 200000
    s_cbranch_scc1 L_poll_5
L_done_6:
    s_cmp_lg_u32 s2, 0
    s_cbranch_scc1 L_noepoch
    v_mov_b32 v2, 0
    s_mov_b64 exec, 1
    buffer_store_dword v139, v2, s[56:59], 0 offen sc1
    s_mov_b64 exec, -1
L_noepoch:
    v_mov_b32 v2, 162776
    v_mov_b32 v3, 1
    s_mov_b64 exec, 1
    ds_add_u32 v2, v3
    s_mov_b64 exec, -1
    s_mov_b32 s76, s30
    s_mov_b32 s77, s31
    s_mov_b32 s78, 1280
    s_mov_b32 s79, 0x20000
    v_lshlrev_b32 v60, 4, v1
    v_add_u32 v61, 1024, v60
    v_cmp_gt_u32 vcc, 16, v1
    s_nop 1
    v_cndmask_b32 v61, v137, v61, vcc
    s_mov_b32 s86, 53248
    s_mov_b32 s87, 57088
    buffer_load_dwordx4 v[88:91], v60, s[76:79], 0 offen
    buffer_load_dwordx4 v[116:119], v61, s[76:79], 0 offen
    s_mul_i32 s10, s8, 10240
    s_mov_b32 s11, 119488
    s_mov_b32 m0, s11
    s_add_u32 s11, s11, 1024
    buffer_load_dwordx4 v60, s[68:71], s10 offen nt lds
    s_add_u32 s10, s10, 1024
    s_mov_b32 m0, s11
    s_add_u32 s11, s11, 1024
    buffer_load_dwordx4 v60, s[68:71], s10 offen nt lds
    s_add_u32 s10, s10, 1024
    s_mov_b32 m0, s11
    s_add_u32 s11, s11, 1024
    buffer_load_dwordx4 v60, s[68:71], s10 offen nt lds
    s_add_u32 s10, s10, 1024
    s_mov_b32 m0, s11
    s_add_u32 s11, s11, 1024
    buffer_load_dwordx4 v60, s[68:71], s10 offen nt lds
    s_add_u32 s10, s10, 1024
    s_mov_b32 m0, s11
    s_add_u32 s11, s11, 1024
    buffer_load_dwordx4 v60, s[68:71], s10 offen nt lds
    s_add_u32 s10, s10, 1024
    s_mov_b32 m0, s11
    s_add_u32 s11, s11, 1024
    buffer_load_dwordx4 v60, s[68:71], s10 offen nt lds
    s_add_u32 s10, s10, 1024
    s_mov_b32 m0, s11
    s_add_u32 s11, s11, 1024
    buffer_load_dwordx4 v60, s[68:71], s10 offen nt lds
    s_add_u32 s10, s10, 1024
    s_mov_b32 m0, s11
    s_add_u32 s11, s11, 1024
    buffer_load_dwordx4 v60, s[68:71], s10 offen nt lds
    s_add_u32 s10, s10, 1024
    s_mov_b32 m0, s11
    s_add_u32 s11, s11, 1024
    buffer_load_dwordx4 v60, s[68:71], s10 offen nt lds
    s_add_u32 s10, s10, 1024
    s_mov_b32 m0, s11
    s_add_u32 s11, s11, 1024
    buffer_load_dwordx4 v60, s[68:71], s10 offen nt lds
    s_add_u32 s10, s10, 1024
    s_mul_i32 s11, s8, 2560
    s_add_u32 s11, s11, 131072
    v_add_u32 v2, s11, v60
    v_add_u32 v3, 2048, v2
    v_cmp_gt_u32 vcc, 32, v1
    s_nop 1
    v_cndmask_b32 v3, v137, v3, vcc
    buffer_store_dwordx4 v[28:31], v2, s[56:59], 0 offen sc1
    buffer_store_dwordx4 v[28:31], v2, s[56:59], 0 offen offset:1024 sc1
    buffer_store_dwordx4 v[28:31], v3, s[56:59], 0 offen sc1
    s_mov_b32 s72, s36
    s_mov_b32 s73, s37
    s_mov_b32 s74, 2211840
    s_mov_b32 s75, 0x20000
    s_and_b32 s11, s2, 7
    s_lshr_b32 s10, s2, 3
    s_add_u32 s11, s11, 2
    s_and_b32 s11, s11, 7
    s_mul_i32 s11, s11, 160
    s_and_b32 s11, s11, 0xffffff80
    s_mul_i32 s10, s10, 111360
    s_add_u32 s10, s10, s11
    s_add_u32 s11, s10, 40960
    s_add_u32 s12, s10, 81920
    v_lshrrev_b32 v2, 1, v1
    v_mul_u32_u24 v2, 1280, v2
    v_and_b32 v3, 1, v1
    v_lshl_add_u32 v2, v3, 7, v2
    buffer_load_dword v4, v2, s[72:75], s10 offen
    buffer_load_dword v4, v2, s[72:75], s11 offen
    buffer_load_dword v4, v2, s[72:75], s12 offen
    s_mov_b32 s72, s32
    s_mov_b32 s73, s33
    s_mov_b32 s74, 2211840
    s_mov_b32 s75, 0x20000
    s_mov_b32 s76, s34
    s_mov_b32 s77, s35
    s_mov_b32 s78, 2211840
    s_mov_b32 s79, 0x20000
    s_and_b32 s11, s2, 7
    s_mul_i32 s12, s11, 7
    s_cmp_eq_u32 s11, 7
    s_cselect_b32 s12, 48, s12
    s_lshr_b32 s12, s12, 1
    s_lshl_b32 s12, s12, 7
    s_lshr_b32 s10, s2, 3
    s_mul_i32 s13, s10, 110592
    s_add_u32 s12, s12, s13
    s_add_u32 s13, s12, 55296
    v_lshrrev_b32 v2, 2, v1
    v_mul_u32_u24 v2, 3456, v2
    v_and_b32 v3, 3, v1
    v_lshl_add_u32 v2, v3, 7, v2
    buffer_load_dword v4, v2, s[72:75], s12 offen
    buffer_load_dword v4, v2, s[76:79], s12 offen
    buffer_load_dword v4, v2, s[72:75], s13 offen
    buffer_load_dword v4, v2, s[76:79], s13 offen
    v_lshrrev_b32 v6, 3, v1
    v_and_b32 v6, 1, v6
    v_lshrrev_b32 v7, 4, v1
    v_and_b32 v7, 2, v7
    v_or_b32 v6, v6, v7
    v_xor_b32 v6, v6, v1
    v_lshlrev_b32 v6, 4, v6
    v_add_u32 v6, 103104, v6
    v_lshrrev_b32 v7, 2, v1
    v_mul_u32_u24 v7, 10240, v7
    v_and_b32 v8, 3, v1
    v_lshl_add_u32 v7, v8, 4, v7
    s_lshl_b32 s10, s7, 6
    s_add_u32 s10, s10, 5242880
    v_add_u32 v7, s10, v7
    v_mov_b32 v2, 162772
    s_mov_b32 s15, 0
L_lw_7:
    ds_read_b32 v3, v2
    s_waitcnt lgkmcnt(0)
    v_cmp_gt_u32 vcc, 4, v3
    s_cbranch_vccz L_lwd_8
    s_sleep 1
    s_add_u32 s15, s15, 1
    s_cmp_lt_u32 s15, 1600000
    s_cbranch_scc1 L_lw_7
L_lwd_8:
    ds_read_b128 v[16:19], v6 offset:0
    ds_read_b128 v[20:23], v6 offset:1024
    ds_read_b128 v[24:27], v6 offset:2048
    ds_read_b128 v[28:31], v6 offset:3072
    ds_read_b128 v[32:35], v6 offset:4096
    ds_read_b128 v[36:39], v6 offset:5120
    ds_read_b128 v[40:43], v6 offset:6144
    ds_read_b128 v[44:47], v6 offset:7168
    ds_read_b128 v[48:51], v6 offset:8192
    ds_read_b128 v[52:55], v6 offset:9216
    s_mov_b32 s10, 0
    s_waitcnt lgkmcnt(9)
    buffer_store_dwordx4 v[16:19], v7, s[56:59], s10 offen sc1
    s_mov_b32 s10, 163840
    s_waitcnt lgkmcnt(8)
    buffer_store_dwordx4 v[20:23], v7, s[56:59], s10 offen sc1
    s_mov_b32 s10, 327680
    s_waitcnt lgkmcnt(7)
    buffer_store_dwordx4 v[24:27], v7, s[56:59], s10 offen sc1
    s_mov_b32 s10, 491520
    s_waitcnt lgkmcnt(6)
    buffer_store_dwordx4 v[28:31], v7, s[56:59], s10 offen sc1
    s_mov_b32 s10, 655360
    s_waitcnt lgkmcnt(5)
    buffer_store_dwordx4 v[32:35], v7, s[56:59], s10 offen sc1
    s_mov_b32 s10, 819200
    s_waitcnt lgkmcnt(4)
    buffer_store_dwordx4 v[36:39], v7, s[56:59], s10 offen sc1
    s_mov_b32 s10, 983040
    s_waitcnt lgkmcnt(3)
    buffer_store_dwordx4 v[40:43], v7, s[56:59], s10 offen sc1
    s_mov_b32 s10, 1146880
    s_waitcnt lgkmcnt(2)
    buffer_store_dwordx4 v[44:47], v7, s[56:59], s10 offen sc1
    s_mov_b32 s10, 1310720
    s_waitcnt lgkmcnt(1)
    buffer_store_dwordx4 v[48:51], v7, s[56:59], s10 offen sc1
    s_mov_b32 s10, 1474560
    s_waitcnt lgkmcnt(0)
    buffer_store_dwordx4 v[52:55], v7, s[56:59], s10 offen sc1
    buffer_load_dwordx4 v[64:67], v60, s[56:59], s86 offen offset:0 sc1
    buffer_load_dwordx4 v[68:71], v60, s[56:59], s86 offen offset:1280 sc1
    buffer_load_dwordx4 v[72:75], v60, s[56:59], s86 offen offset:2560 sc1
    buffer_load_dwordx4 v[76:79], v60, s[56:59], s87 offen offset:0 sc1
    buffer_load_dwordx4 v[80:83], v60, s[56:59], s87 offen offset:1280 sc1
    buffer_load_dwordx4 v[84:87], v60, s[56:59], s87 offen offset:2560 sc1
    buffer_load_dwordx4 v[92:95], v61, s[56:59], s86 offen offset:0 sc1
    buffer_load_dwordx4 v[96:99], v61, s[56:59], s86 offen offset:1280 sc1
    buffer_load_dwordx4 v[100:103], v61, s[56:59], s86 offen offset:2560 sc1
    buffer_load_dwordx4 v[104:107], v61, s[56:59], s87 offen offset:0 sc1
    buffer_load_dwordx4 v[108:111], v61, s[56:59], s87 offen offset:1280 sc1
    buffer_load_dwordx4 v[112:115], v61, s[56:59], s87 offen offset:2560 sc1
    s_lshl_b32 s10, s7, 6
    s_add_u32 s10, s10, 73728
    v_mov_b32 v2, s10
    s_waitcnt vmcnt(0)
    s_mov_b64 exec, 1
    buffer_store_dword v139, v2, s[56:59], 0 offen sc1
    v_mov_b32 v2, 162780
    v_mov_b32 v3, 1
    s_mov_b64 exec, 1
    ds_add_u32 v2, v3
    s_mov_b64 exec, -1
    s_mov_b32 s15, 0
L_rp_9:
    v_max3_u32 v4, v64, v65, v66
    v_max3_u32 v4, v4, v67, v68
    v_max3_u32 v4, v4, v69, v70
    v_max3_u32 v4, v4, v71, v72
    v_max3_u32 v4, v4, v73, v74
    v_max3_u32 v4, v4, v75, v76
    v_max3_u32 v4, v4, v77, v78
    v_max3_u32 v4, v4, v79, v80
    v_max3_u32 v4, v4, v81, v82
    v_max3_u32 v4, v4, v83, v84
    v_max3_u32 v4, v4, v85, v86
    v_max3_u32 v4, v4, v87, v92
    v_max3_u32 v4, v4, v93, v94
    v_max3_u32 v4, v4, v95, v96
    v_max3_u32 v4, v4, v97, v98
    v_max3_u32 v4, v4, v99, v100
    v_max3_u32 v4, v4, v101, v102
    v_max3_u32 v4, v4, v103, v104
    v_max3_u32 v4, v4, v105, v106
    v_max3_u32 v4, v4, v107, v108
    v_max3_u32 v4, v4, v109, v110
    v_max3_u32 v4, v4, v111, v112
    v_max3_u32 v4, v4, v113, v114
    v_max_u32 v4, v4, v115
    v_cmp_eq_u32 vcc, -1, v4
    s_cbranch_vccz L_rpd_10
    s_sleep 6
    s_add_u32 s15, s15, 1
    s_cmp_ge_u32 s15, 200000
    s_cbranch_scc1 L_rpd_10
    buffer_load_dwordx4 v[64:67], v60, s[56:59], s86 offen offset:0 sc1
    buffer_load_dwordx4 v[68:71], v60, s[56:59], s86 offen offset:1280 sc1
    buffer_load_dwordx4 v[72:75], v60, s[56:59], s86 offen offset:2560 sc1
    buffer_load_dwordx4 v[76:79], v60, s[56:59], s87 offen offset:0 sc1
    buffer_load_dwordx4 v[80:83], v60, s[56:59], s87 offen offset:1280 sc1
    buffer_load_dwordx4 v[84:87], v60, s[56:59], s87 offen offset:2560 sc1
    buffer_load_dwordx4 v[92:95], v61, s[56:59], s86 offen offset:0 sc1
    buffer_load_dwordx4 v[96:99], v61, s[56:59], s86 offen offset:1280 sc1
    buffer_load_dwordx4 v[100:103], v61, s[56:59], s86 offen offset:2560 sc1
    buffer_load_dwordx4 v[104:107], v61, s[56:59], s87 offen offset:0 sc1
    buffer_load_dwordx4 v[108:111], v61, s[56:59], s87 offen offset:1280 sc1
    buffer_load_dwordx4 v[112:115], v61, s[56:59], s87 offen offset:2560 sc1
    s_waitcnt vmcnt(0)
    s_branch L_rp_9
L_rpd_10:
    v_lshlrev_b32 v62, 5, v1
    v_add_u32 v62, 140064, v62
    v_lshlrev_b32 v16, 16, v68
    v_and_b32 v17, 0xffff0000, v68
    v_lshlrev_b32 v18, 16, v69
    v_and_b32 v19, 0xffff0000, v69
    v_lshlrev_b32 v20, 16, v70
    v_and_b32 v21, 0xffff0000, v70
    v_lshlrev_b32 v22, 16, v71
    v_and_b32 v23, 0xffff0000, v71
    v_pk_add_f32 v[16:17], v[16:17], 1.0 op_sel_hi:[1,0]
    v_pk_add_f32 v[18:19], v[18:19], 1.0 op_sel_hi:[1,0]
    v_pk_add_f32 v[20:21], v[20:21], 1.0 op_sel_hi:[1,0]
    v_pk_add_f32 v[22:23], v[22:23], 1.0 op_sel_hi:[1,0]
    ds_write_b128 v62, v[16:19] offset:0
    ds_write_b128 v62, v[20:23] offset:16
    v_lshlrev_b32 v24, 16, v64
    v_and_b32 v25, 0xffff0000, v64
    v_lshlrev_b32 v26, 16, v65
    v_and_b32 v27, 0xffff0000, v65
    v_lshlrev_b32 v28, 16, v66
    v_and_b32 v29, 0xffff0000, v66
    v_lshlrev_b32 v30, 16, v67
    v_and_b32 v31, 0xffff0000, v67
    ds_write_b128 v62, v[24:27] offset:2560
    ds_write_b128 v62, v[28:31] offset:2576
    v_lshlrev_b32 v16, 16, v72
    v_and_b32 v17, 0xffff0000, v72
    v_lshlrev_b32 v18, 16, v73
    v_and_b32 v19, 0xffff0000, v73
    v_lshlrev_b32 v20, 16, v74
    v_and_b32 v21, 0xffff0000, v74
    v_lshlrev_b32 v22, 16, v75
    v_and_b32 v23, 0xffff0000, v75
    ds_write_b128 v62, v[16:19] offset:5120
    ds_write_b128 v62, v[20:23] offset:5136
    v_lshlrev_b32 v24, 16, v84
    v_and_b32 v25, 0xffff0000, v84
    v_lshlrev_b32 v26, 16, v85
    v_and_b32 v27, 0xffff0000, v85
    v_lshlrev_b32 v28, 16, v86
    v_and_b32 v29, 0xffff0000, v86
    v_lshlrev_b32 v30, 16, v87
    v_and_b32 v31, 0xffff0000, v87
    ds_write_b128 v62, v[24:27] offset:12800
    ds_write_b128 v62, v[28:31] offset:12816
    v_lshlrev_b32 v32, 16, v80
    v_and_b32 v33, 0xffff0000, v80
    v_lshlrev_b32 v34, 16, v81
    v_and_b32 v35, 0xffff0000, v81
    v_lshlrev_b32 v36, 16, v82
    v_and_b32 v37, 0xffff0000, v82
    v_lshlrev_b32 v38, 16, v83
    v_and_b32 v39, 0xffff0000, v83
    v_pk_add_f32 v[32:33], v[32:33], 1.0 op_sel_hi:[1,0]
    v_pk_add_f32 v[34:35], v[34:35], 1.0 op_sel_hi:[1,0]
    v_pk_add_f32 v[36:37], v[36:37], 1.0 op_sel_hi:[1,0]
    v_pk_add_f32 v[38:39], v[38:39], 1.0 op_sel_hi:[1,0]
    ds_write_b128 v62, v[32:35] offset:7680
    ds_write_b128 v62, v[36:39] offset:7696
    v_lshlrev_b32 v40, 16, v76
    v_and_b32 v41, 0xffff0000, v76
    v_lshlrev_b32 v42, 16, v77
    v_and_b32 v43, 0xffff0000, v77
    v_lshlrev_b32 v44, 16, v78
    v_and_b32 v45, 0xffff0000, v78
    v_lshlrev_b32 v46, 16, v79
    v_and_b32 v47, 0xffff0000, v79
    ds_write_b128 v62, v[40:43] offset:10240
    ds_write_b128 v62, v[44:47] offset:10256
    v_lshlrev_b32 v16, 16, v88
    v_and_b32 v17, 0xffff0000, v88
    v_lshlrev_b32 v18, 16, v89
    v_and_b32 v19, 0xffff0000, v89
    v_lshlrev_b32 v20, 16, v90
    v_and_b32 v21, 0xffff0000, v90
    v_lshlrev_b32 v22, 16, v91
    v_and_b32 v23, 0xffff0000, v91
    v_pk_mul_f32 v[24:25], v[32:33], v[16:17]
    v_pk_mul_f32 v[26:27], v[34:35], v[18:19]
    v_pk_mul_f32 v[28:29], v[36:37], v[20:21]
    v_pk_mul_f32 v[30:31], v[38:39], v[22:23]
    ds_write_b128 v62, v[24:27] offset:15360
    ds_write_b128 v62, v[28:31] offset:15376
    v_pk_mul_f32 v[50:51], v[40:41], v[16:17]
    v_pk_add_f32 v[48:49], v[24:25], 0 op_sel_hi:[1,0]
    v_pk_fma_f32 v[50:51], v[42:43], v[18:19], v[50:51]
    v_pk_add_f32 v[48:49], v[48:49], v[26:27]
    v_pk_fma_f32 v[50:51], v[44:45], v[20:21], v[50:51]
    v_pk_add_f32 v[48:49], v[48:49], v[28:29]
    v_pk_fma_f32 v[50:51], v[46:47], v[22:23], v[50:51]
    v_pk_add_f32 v[48:49], v[48:49], v[30:31]
    s_mov_b64 exec, 0xffff
    v_lshlrev_b32 v16, 16, v96
    v_and_b32 v17, 0xffff0000, v96
    v_lshlrev_b32 v18, 16, v97
    v_and_b32 v19, 0xffff0000, v97
    v_lshlrev_b32 v20, 16, v98
    v_and_b32 v21, 0xffff0000, v98
    v_lshlrev_b32 v22, 16, v99
    v_and_b32 v23, 0xffff0000, v99
    v_pk_add_f32 v[16:17], v[16:17], 1.0 op_sel_hi:[1,0]
    v_pk_add_f32 v[18:19], v[18:19], 1.0 op_sel_hi:[1,0]
    v_pk_add_f32 v[20:21], v[20:21], 1.0 op_sel_hi:[1,0]
    v_pk_add_f32 v[22:23], v[22:23], 1.0 op_sel_hi:[1,0]
    ds_write_b128 v62, v[16:19] offset:2048
    ds_write_b128 v62, v[20:23] offset:2064
    v_lshlrev_b32 v24, 16, v92
    v_and_b32 v25, 0xffff0000, v92
    v_lshlrev_b32 v26, 16, v93
    v_and_b32 v27, 0xffff0000, v93
    v_lshlrev_b32 v28, 16, v94
    v_and_b32 v29, 0xffff0000, v94
    v_lshlrev_b32 v30, 16, v95
    v_and_b32 v31, 0xffff0000, v95
    ds_write_b128 v62, v[24:27] offset:4608
    ds_write_b128 v62, v[28:31] offset:4624
    v_lshlrev_b32 v16, 16, v100
    v_and_b32 v17, 0xffff0000, v100
    v_lshlrev_b32 v18, 16, v101
    v_and_b32 v19, 0xffff0000, v101
    v_lshlrev_b32 v20, 16, v102
    v_and_b32 v21, 0xffff0000, v102
    v_lshlrev_b32 v22, 16, v103
    v_and_b32 v23, 0xffff0000, v103
    ds_write_b128 v62, v[16:19] offset:7168
    ds_write_b128 v62, v[20:23] offset:7184
    v_lshlrev_b32 v24, 16, v112
    v_and_b32 v25, 0xffff0000, v112
    v_lshlrev_b32 v26, 16, v113
    v_and_b32 v27, 0xffff0000, v113
    v_lshlrev_b32 v28, 16, v114
    v_and_b32 v29, 0xffff0000, v114
    v_lshlrev_b32 v30, 16, v115
    v_and_b32 v31, 0xffff0000, v115
    ds_write_b128 v62, v[24:27] offset:14848
    ds_write_b128 v62, v[28:31] offset:14864
    v_lshlrev_b32 v32, 16, v108
    v_and_b32 v33, 0xffff0000, v108
    v_lshlrev_b32 v34, 16, v109
    v_and_b32 v35, 0xffff0000, v109
    v_lshlrev_b32 v36, 16, v110
    v_and_b32 v37, 0xffff0000, v110
    v_lshlrev_b32 v38, 16, v111
    v_and_b32 v39, 0xffff0000, v111
    v_pk_add_f32 v[32:33], v[32:33], 1.0 op_sel_hi:[1,0]
    v_pk_add_f32 v[34:35], v[34:35], 1.0 op_sel_hi:[1,0]
    v_pk_add_f32 v[36:37], v[36:37], 1.0 op_sel_hi:[1,0]
    v_pk_add_f32 v[38:39], v[38:39], 1.0 op_sel_hi:[1,0]
    ds_write_b128 v62, v[32:35] offset:9728
    ds_write_b128 v62, v[36:39] offset:9744
    v_lshlrev_b32 v40, 16, v104
    v_and_b32 v41, 0xffff0000, v104
    v_lshlrev_b32 v42, 16, v105
    v_and_b32 v43, 0xffff0000, v105
    v_lshlrev_b32 v44, 16, v106
    v_and_b32 v45, 0xffff0000, v106
    v_lshlrev_b32 v46, 16, v107
    v_and_b32 v47, 0xffff0000, v107
    ds_write_b128 v62, v[40:43] offset:12288
    ds_write_b128 v62, v[44:47] offset:12304
    v_lshlrev_b32 v16, 16, v116
    v_and_b32 v17, 0xffff0000, v116
    v_lshlrev_b32 v18, 16, v117
    v_and_b32 v19, 0xffff0000, v117
    v_lshlrev_b32 v20, 16, v118
    v_and_b32 v21, 0xffff0000, v118
    v_lshlrev_b32 v22, 16, v119
    v_and_b32 v23, 0xffff0000, v119
    v_pk_mul_f32 v[24:25], v[32:33], v[16:17]
    v_pk_mul_f32 v[26:27], v[34:35], v[18:19]
    v_pk_mul_f32 v[28:29], v[36:37], v[20:21]
    v_pk_mul_f32 v[30:31], v[38:39], v[22:23]
    ds_write_b128 v62, v[24:27] offset:17408
    ds_write_b128 v62, v[28:31] offset:17424
    v_pk_fma_f32 v[50:51], v[40:41], v[16:17], v[50:51]
    v_pk_add_f32 v[48:49], v[48:49], v[24:25]
    v_pk_fma_f32 v[50:51], v[42:43], v[18:19], v[50:51]
    v_pk_add_f32 v[48:49], v[48:49], v[26:27]
    v_pk_fma_f32 v[50:51], v[44:45], v[20:21], v[50:51]
    v_pk_add_f32 v[48:49], v[48:49], v[28:29]
    v_pk_fma_f32 v[50:51], v[46:47], v[22:23], v[50:51]
    v_pk_add_f32 v[48:49], v[48:49], v[30:31]
    s_mov_b64 exec, -1
    v_add_f32 v48, v48, v49
    v_add_f32 v50, v50, v51
    v_lshrrev_b32 v49, 5, v1
    v_lshlrev_b32 v49, 2, v49
    v_permlane32_swap_b32 v48, v50
    v_add_f32 v48, v48, v50
    v_add_u32 v49, 161984, v49
    v_mov_b32 v50, v48
    s_nop 1
    v_permlane16_swap_b32 v48, v50
    v_add_f32 v48, v48, v50
    s_nop 1
    v_add_f32_dpp v48, v48, v48 row_ror:8 row_mask:0xf bank_mask:0xf
    s_nop 1
    v_add_f32_dpp v48, v48, v48 row_ror:4 row_mask:0xf bank_mask:0xf
    s_nop 1
    v_add_f32_dpp v48, v48, v48 row_ror:2 row_mask:0xf bank_mask:0xf
    s_nop 1
    v_add_f32_dpp v48, v48, v48 row_ror:1 row_mask:0xf bank_mask:0xf
    ds_write_b32 v49, v48
    v_lshlrev_b32 v2, 6, v1
    v_add_u32 v2, 73728, v2
    v_min_u32 v3, 31, v1
    v_lshlrev_b32 v3, 6, v3
    v_add_u32 v3, 81920, v3
    s_movk_i32 s10, 4096
    s_mov_b32 s15, 0
L_poll_11:
    buffer_load_dword v4, v2, s[56:59], 0 offen sc1
    buffer_load_dword v5, v2, s[56:59], s10 offen sc1
    buffer_load_dword v6, v3, s[56:59], 0 offen sc1
    s_waitcnt vmcnt(0)
    v_xor_b32 v4, s4, v4
    v_xor_b32 v5, s4, v5
    v_xor_b32 v6, s4, v6
    v_or3_b32 v4, v4, v5, v6
    v_cmp_ne_u32 vcc, 0, v4
    s_cbranch_vccz L_done_12
    s_sleep 2
    s_add_u32 s15, s15, 1
    s_cmp_lt_u32 s15, 200000
    s_cbranch_scc1 L_poll_11
L_done_12:
    s_waitcnt lgkmcnt(0)
    s_barrier
    s_branch L_row_w4
L_nonconv:
    s_cmp_lt_u32 s7, 94
    s_cbranch_scc1 L_nc_nored
    v_lshlrev_b32 v2, 6, v1
    v_add_u32 v2, 4096, v2
    s_movk_i32 s10, 4096
    s_movk_i32 s11, 8192
    s_movk_i32 s12, 12288
    s_mov_b32 s15, 0
L_poll_13:
    buffer_load_dword v3, v2, s[56:59], 0 offen sc1
    buffer_load_dword v4, v2, s[56:59], s10 offen sc1
    buffer_load_dword v5, v2, s[56:59], s11 offen sc1
    buffer_load_dword v6, v2, s[56:59], s12 offen sc1
    s_waitcnt vmcnt(0)
    v_xor_b32 v3, s4, v3
    v_xor_b32 v4, s4, v4
    v_xor_b32 v5, s4, v5
    v_xor_b32 v6, s4, v6
    v_or3_b32 v3, v3, v4, v5
    v_or_b32 v3, v3, v6
    v_cmp_ne_u32 vcc, 0, v3
    s_cbranch_vccz L_done_14
    s_sleep 2
    s_add_u32 s15, s15, 1
    s_cmp_lt_u32 s15, 200000
    s_cbranch_scc1 L_poll_13
L_done_14:
    s_sub_u32 s10, s7, 94
    s_mul_i32 s10, s10, 5
    s_add_u32 s10, s10, s3
    s_mul_i32 s10, s10, 6
    s_lshl_b32 s11, s10, 10
    s_add_u32 s11, s11, 1441792
    v_lshlrev_b32 v6, 4, v1
    v_add_u32 v6, s11, v6
    s_lshl_b32 s10, s10, 7
    s_add_u32 s10, s10, 53248
    v_and_b32 v7, 15, v1
    v_lshlrev_b32 v7, 3, v7
    v_lshrrev_b32 v8, 5, v1
    v_lshl_add_u32 v7, v8, 2, v7
    v_add_u32 v7, s10, v7
    s_movk_i32 s10, 4096
    s_mov_b32 s15, 0
L_poll_15:
    buffer_load_dwordx4 v[32:35], v6, s[56:59], 0 offen offset:0 sc1
    buffer_load_dwordx4 v[36:39], v6, s[56:59], 0 offen offset:1024 sc1
    buffer_load_dwordx4 v[40:43], v6, s[56:59], 0 offen offset:2048 sc1
    buffer_load_dwordx4 v[44:47], v6, s[56:59], 0 offen offset:3072 sc1
    buffer_load_dwordx4 v[48:51], v6, s[56:59], s10 offen offset:0 sc1
    buffer_load_dwordx4 v[52:55], v6, s[56:59], s10 offen offset:1024 sc1
    s_waitcnt vmcnt(0)
    v_max3_u32 v4, v32, v33, v34
    v_max3_u32 v4, v4, v35, v36
    v_max3_u32 v4, v4, v37, v38
    v_max3_u32 v4, v4, v39, v40
    v_max3_u32 v4, v4, v41, v42
    v_max3_u32 v4, v4, v43, v44
    v_max3_u32 v4, v4, v45, v46
    v_max3_u32 v4, v4, v47, v48
    v_max3_u32 v4, v4, v49, v50
    v_max3_u32 v4, v4, v51, v52
    v_max3_u32 v4, v4, v53, v54
    v_max_u32 v4, v4, v55
    v_cmp_eq_u32 vcc, -1, v4
    s_cbranch_vccz L_done_16
    s_sleep 2
    s_add_u32 s15, s15, 1
    s_cmp_lt_u32 s15, 200000
    s_cbranch_scc1 L_poll_15
L_done_16:
    v_permlane32_swap_b32 v32, v34
    v_permlane32_swap_b32 v33, v35
    v_permlane32_swap_b32 v36, v38
    v_permlane32_swap_b32 v37, v39
    v_permlane32_swap_b32 v40, v42
    v_permlane32_swap_b32 v41, v43
    v_permlane32_swap_b32 v44, v46
    v_permlane32_swap_b32 v45, v47
    v_permlane32_swap_b32 v48, v50
    v_permlane32_swap_b32 v49, v51
    v_permlane32_swap_b32 v52, v54
    v_permlane32_swap_b32 v53, v55
    v_pk_add_f32 v[32:33], v[32:33], v[34:35]
    v_mov_b32 v34, v32
    v_mov_b32 v35, v33
    v_pk_add_f32 v[36:37], v[36:37], v[38:39]
    v_mov_b32 v38, v36
    v_mov_b32 v39, v37
    v_pk_add_f32 v[40:41], v[40:41], v[42:43]
    v_mov_b32 v42, v40
    v_mov_b32 v43, v41
    v_pk_add_f32 v[44:45], v[44:45], v[46:47]
    v_mov_b32 v46, v44
    v_mov_b32 v47, v45
    v_pk_add_f32 v[48:49], v[48:49], v[50:51]
    v_mov_b32 v50, v48
    v_mov_b32 v51, v49
    v_pk_add_f32 v[52:53], v[52:53], v[54:55]
    v_mov_b32 v54, v52
    v_mov_b32 v55, v53
    v_permlane16_swap_b32 v32, v34
    v_permlane16_swap_b32 v33, v35
    v_permlane16_swap_b32 v36, v38
    v_permlane16_swap_b32 v37, v39
    v_permlane16_swap_b32 v40, v42
    v_permlane16_swap_b32 v41, v43
    v_permlane16_swap_b32 v44, v46
    v_permlane16_swap_b32 v45, v47
    v_permlane16_swap_b32 v48, v50
    v_permlane16_swap_b32 v49, v51
    v_permlane16_swap_b32 v52, v54
    v_permlane16_swap_b32 v53, v55
    v_pk_add_f32 v[32:33], v[32:33], v[34:35]
    v_cvt_pk_bf16_f32 v32, v32, v33
    v_pk_add_f32 v[36:37], v[36:37], v[38:39]
    v_cvt_pk_bf16_f32 v36, v36, v37
    v_pk_add_f32 v[40:41], v[40:41], v[42:43]
    v_cvt_pk_bf16_f32 v40, v40, v41
    v_pk_add_f32 v[44:45], v[44:45], v[46:47]
    v_cvt_pk_bf16_f32 v44, v44, v45
    v_pk_add_f32 v[48:49], v[48:49], v[50:51]
    v_cvt_pk_bf16_f32 v48, v48, v49
    v_pk_add_f32 v[52:53], v[52:53], v[54:55]
    v_cvt_pk_bf16_f32 v52, v52, v53
    s_mov_b32 exec_lo, 0xffff
    s_mov_b32 exec_hi, 0xffff
    buffer_store_dword v32, v7, s[56:59], 0 offen offset:0 sc1
    buffer_store_dword v36, v7, s[56:59], 0 offen offset:128 sc1
    buffer_store_dword v40, v7, s[56:59], 0 offen offset:256 sc1
    buffer_store_dword v44, v7, s[56:59], 0 offen offset:384 sc1
    buffer_store_dword v48, v7, s[56:59], 0 offen offset:512 sc1
    buffer_store_dword v52, v7, s[56:59], 0 offen offset:640 sc1
    s_mov_b64 exec, -1
L_nc_nored:
    s_cmp_eq_u32 s3, 4
    s_cbranch_scc1 L_nc_w4
L_nc_nomod:
    buffer_load_dwordx2 v[140:141], v131, s[68:71], 0 offen offset:0 nt
    buffer_load_dwordx2 v[142:143], v131, s[68:71], 0 offen offset:64 nt
    buffer_load_dwordx2 v[144:145], v131, s[68:71], 0 offen offset:128 nt
    buffer_load_dwordx2 v[146:147], v131, s[68:71], 0 offen offset:192 nt
    buffer_load_dwordx2 v[148:149], v131, s[68:71], 0 offen offset:256 nt
    buffer_store_dwordx4 v[28:31], v124, s[56:59], 0 offen sc1
    v_lshlrev_b32 v151, 5, v133
    v_add_u32 v151, 161216, v151
    v_lshrrev_b32 v150, 5, v1
    v_lshlrev_b32 v150, 2, v150
    s_lshl_b32 s10, s3, 3
    v_add3_u32 v150, v150, s10, v151
    s_cmp_lg_u32 s3, 1
    s_cbranch_scc1 L_nc_ln1
    s_mov_b32 s76, s30
    s_mov_b32 s77, s31
    s_mov_b32 s78, 1280
    s_mov_b32 s79, 0x20000
    v_lshlrev_b32 v60, 4, v1
    v_add_u32 v61, 1024, v60
    v_cmp_gt_u32 vcc, 16, v1
    s_nop 1
    v_cndmask_b32 v61, v137, v61, vcc
    s_mov_b32 s86, 53248
    s_mov_b32 s87, 57088
    buffer_load_dwordx4 v[88:91], v60, s[76:79], 0 offen
    buffer_load_dwordx4 v[116:119], v61, s[76:79], 0 offen
    s_sleep 40
    v_lshlrev_b32 v2, 6, v1
    v_add_u32 v2, 4096, v2
    s_movk_i32 s10, 4096
    s_movk_i32 s11, 8192
    s_movk_i32 s12, 12288
    s_mov_b32 s15, 0
L_poll_17:
    buffer_load_dword v3, v2, s[56:59], 0 offen sc1
    buffer_load_dword v4, v2, s[56:59], s10 offen sc1
    buffer_load_dword v5, v2, s[56:59], s11 offen sc1
    buffer_load_dword v6, v2, s[56:59], s12 offen sc1
    s_waitcnt vmcnt(0)
    v_xor_b32 v3, s4, v3
    v_xor_b32 v4, s4, v4
    v_xor_b32 v5, s4, v5
    v_xor_b32 v6, s4, v6
    v_or3_b32 v3, v3, v4, v5
    v_or_b32 v3, v3, v6
    v_cmp_ne_u32 vcc, 0, v3
    s_cbranch_vccz L_done_18
    s_sleep 8
    s_add_u32 s15, s15, 1
    s_cmp_lt_u32 s15, 200000
    s_cbranch_scc1 L_poll_17
L_done_18:
    v_min_u32 v2, 59, v1
    v_lshlrev_b32 v2, 7, v2
    v_add_u32 v2, 53248, v2
    s_mov_b32 s15, 0
L_poll_19:
    buffer_load_dword v3, v2, s[56:59], 0 offen sc1
    s_waitcnt vmcnt(0)
    v_cmp_eq_u32 vcc, -1, v3
    s_cbranch_vccz L_done_20
    s_sleep 16
    s_add_u32 s15, s15, 1
    s_cmp_lt_u32 s15, 200000
    s_cbranch_scc1 L_poll_19
L_done_20:
    s_mov_b32 s15, 0
L_poll_21:
    buffer_load_dwordx4 v[64:67], v60, s[56:59], s86 offen offset:0 sc1
    buffer_load_dwordx4 v[68:71], v60, s[56:59], s86 offen offset:1280 sc1
    buffer_load_dwordx4 v[72:75], v60, s[56:59], s86 offen offset:2560 sc1
    buffer_load_dwordx4 v[76:79], v60, s[56:59], s87 offen offset:0 sc1
    buffer_load_dwordx4 v[80:83], v60, s[56:59], s87 offen offset:1280 sc1
    buffer_load_dwordx4 v[84:87], v60, s[56:59], s87 offen offset:2560 sc1
    buffer_load_dwordx4 v[92:95], v61, s[56:59], s86 offen offset:0 sc1
    buffer_load_dwordx4 v[96:99], v61, s[56:59], s86 offen offset:1280 sc1
    buffer_load_dwordx4 v[100:103], v61, s[56:59], s86 offen offset:2560 sc1
    buffer_load_dwordx4 v[104:107], v61, s[56:59], s87 offen offset:0 sc1
    buffer_load_dwordx4 v[108:111], v61, s[56:59], s87 offen offset:1280 sc1
    buffer_load_dwordx4 v[112:115], v61, s[56:59], s87 offen offset:2560 sc1
    s_waitcnt vmcnt(0)
    v_max3_u32 v4, v64, v65, v66
    v_max3_u32 v4, v4, v67, v68
    v_max3_u32 v4, v4, v69, v70
    v_max3_u32 v4, v4, v71, v72
    v_max3_u32 v4, v4, v73, v74
    v_max3_u32 v4, v4, v75, v76
    v_max3_u32 v4, v4, v77, v78
    v_max3_u32 v4, v4, v79, v80
    v_max3_u32 v4, v4, v81, v82
    v_max3_u32 v4, v4, v83, v84
    v_max3_u32 v4, v4, v85, v86
    v_max3_u32 v4, v4, v87, v92
    v_max3_u32 v4, v4, v93, v94
    v_max3_u32 v4, v4, v95, v96
    v_max3_u32 v4, v4, v97, v98
    v_max3_u32 v4, v4, v99, v100
    v_max3_u32 v4, v4, v101, v102
    v_max3_u32 v4, v4, v103, v104
    v_max3_u32 v4, v4, v105, v106
    v_max3_u32 v4, v4, v107, v108
    v_max3_u32 v4, v4, v109, v110
    v_max3_u32 v4, v4, v111, v112
    v_max3_u32 v4, v4, v113, v114
    v_max_u32 v4, v4, v115
    v_cmp_eq_u32 vcc, -1, v4
    s_cbranch_vccz L_done_22
    s_sleep 6
    s_add_u32 s15, s15, 1
    s_cmp_lt_u32 s15, 200000
    s_cbranch_scc1 L_poll_21
L_done_22:
    v_lshlrev_b32 v62, 5, v1
    v_add_u32 v62, 140064, v62
    v_lshlrev_b32 v16, 16, v68
    v_and_b32 v17, 0xffff0000, v68
    v_lshlrev_b32 v18, 16, v69
    v_and_b32 v19, 0xffff0000, v69
    v_lshlrev_b32 v20, 16, v70
    v_and_b32 v21, 0xffff0000, v70
    v_lshlrev_b32 v22, 16, v71
    v_and_b32 v23, 0xffff0000, v71
    v_pk_add_f32 v[16:17], v[16:17], 1.0 op_sel_hi:[1,0]
    v_pk_add_f32 v[18:19], v[18:19], 1.0 op_sel_hi:[1,0]
    v_pk_add_f32 v[20:21], v[20:21], 1.0 op_sel_hi:[1,0]
    v_pk_add_f32 v[22:23], v[22:23], 1.0 op_sel_hi:[1,0]
    ds_write_b128 v62, v[16:19] offset:0
    ds_write_b128 v62, v[20:23] offset:16
    v_lshlrev_b32 v24, 16, v64
    v_and_b32 v25, 0xffff0000, v64
    v_lshlrev_b32 v26, 16, v65
    v_and_b32 v27, 0xffff0000, v65
    v_lshlrev_b32 v28, 16, v66
    v_and_b32 v29, 0xffff0000, v66
    v_lshlrev_b32 v30, 16, v67
    v_and_b32 v31, 0xffff0000, v67
    ds_write_b128 v62, v[24:27] offset:2560
    ds_write_b128 v62, v[28:31] offset:2576
    v_lshlrev_b32 v16, 16, v72
    v_and_b32 v17, 0xffff0000, v72
    v_lshlrev_b32 v18, 16, v73
    v_and_b32 v19, 0xffff0000, v73
    v_lshlrev_b32 v20, 16, v74
    v_and_b32 v21, 0xffff0000, v74
    v_lshlrev_b32 v22, 16, v75
    v_and_b32 v23, 0xffff0000, v75
    ds_write_b128 v62, v[16:19] offset:5120
    ds_write_b128 v62, v[20:23] offset:5136
    v_lshlrev_b32 v24, 16, v84
    v_and_b32 v25, 0xffff0000, v84
    v_lshlrev_b32 v26, 16, v85
    v_and_b32 v27, 0xffff0000, v85
    v_lshlrev_b32 v28, 16, v86
    v_and_b32 v29, 0xffff0000, v86
    v_lshlrev_b32 v30, 16, v87
    v_and_b32 v31, 0xffff0000, v87
    ds_write_b128 v62, v[24:27] offset:12800
    ds_write_b128 v62, v[28:31] offset:12816
    v_lshlrev_b32 v32, 16, v80
    v_and_b32 v33, 0xffff0000, v80
    v_lshlrev_b32 v34, 16, v81
    v_and_b32 v35, 0xffff0000, v81
    v_lshlrev_b32 v36, 16, v82
    v_and_b32 v37, 0xffff0000, v82
    v_lshlrev_b32 v38, 16, v83
    v_and_b32 v39, 0xffff0000, v83
    v_pk_add_f32 v[32:33], v[32:33], 1.0 op_sel_hi:[1,0]
    v_pk_add_f32 v[34:35], v[34:35], 1.0 op_sel_hi:[1,0]
    v_pk_add_f32 v[36:37], v[36:37], 1.0 op_sel_hi:[1,0]
    v_pk_add_f32 v[38:39], v[38:39], 1.0 op_sel_hi:[1,0]
    ds_write_b128 v62, v[32:35] offset:7680
    ds_write_b128 v62, v[36:39] offset:7696
    v_lshlrev_b32 v40, 16, v76
    v_and_b32 v41, 0xffff0000, v76
    v_lshlrev_b32 v42, 16, v77
    v_and_b32 v43, 0xffff0000, v77
    v_lshlrev_b32 v44, 16, v78
    v_and_b32 v45, 0xffff0000, v78
    v_lshlrev_b32 v46, 16, v79
    v_and_b32 v47, 0xffff0000, v79
    ds_write_b128 v62, v[40:43] offset:10240
    ds_write_b128 v62, v[44:47] offset:10256
    v_lshlrev_b32 v16, 16, v88
    v_and_b32 v17, 0xffff0000, v88
    v_lshlrev_b32 v18, 16, v89
    v_and_b32 v19, 0xffff0000, v89
    v_lshlrev_b32 v20, 16, v90
    v_and_b32 v21, 0xffff0000, v90
    v_lshlrev_b32 v22, 16, v91
    v_and_b32 v23, 0xffff0000, v91
    v_pk_mul_f32 v[24:25], v[32:33], v[16:17]
    v_pk_mul_f32 v[26:27], v[34:35], v[18:19]
    v_pk_mul_f32 v[28:29], v[36:37], v[20:21]
    v_pk_mul_f32 v[30:31], v[38:39], v[22:23]
    ds_write_b128 v62, v[24:27] offset:15360
    ds_write_b128 v62, v[28:31] offset:15376
    v_pk_mul_f32 v[50:51], v[40:41], v[16:17]
    v_pk_add_f32 v[48:49], v[24:25], 0 op_sel_hi:[1,0]
    v_pk_fma_f32 v[50:51], v[42:43], v[18:19], v[50:51]
    v_pk_add_f32 v[48:49], v[48:49], v[26:27]
    v_pk_fma_f32 v[50:51], v[44:45], v[20:21], v[50:51]
    v_pk_add_f32 v[48:49], v[48:49], v[28:29]
    v_pk_fma_f32 v[50:51], v[46:47], v[22:23], v[50:51]
    v_pk_add_f32 v[48:49], v[48:49], v[30:31]
    s_mov_b64 exec, 0xffff
    v_lshlrev_b32 v16, 16, v96
    v_and_b32 v17, 0xffff0000, v96
    v_lshlrev_b32 v18, 16, v97
    v_and_b32 v19, 0xffff0000, v97
    v_lshlrev_b32 v20, 16, v98
    v_and_b32 v21, 0xffff0000, v98
    v_lshlrev_b32 v22, 16, v99
    v_and_b32 v23, 0xffff0000, v99
    v_pk_add_f32 v[16:17], v[16:17], 1.0 op_sel_hi:[1,0]
    v_pk_add_f32 v[18:19], v[18:19], 1.0 op_sel_hi:[1,0]
    v_pk_add_f32 v[20:21], v[20:21], 1.0 op_sel_hi:[1,0]
    v_pk_add_f32 v[22:23], v[22:23], 1.0 op_sel_hi:[1,0]
    ds_write_b128 v62, v[16:19] offset:2048
    ds_write_b128 v62, v[20:23] offset:2064
    v_lshlrev_b32 v24, 16, v92
    v_and_b32 v25, 0xffff0000, v92
    v_lshlrev_b32 v26, 16, v93
    v_and_b32 v27, 0xffff0000, v93
    v_lshlrev_b32 v28, 16, v94
    v_and_b32 v29, 0xffff0000, v94
    v_lshlrev_b32 v30, 16, v95
    v_and_b32 v31, 0xffff0000, v95
    ds_write_b128 v62, v[24:27] offset:4608
    ds_write_b128 v62, v[28:31] offset:4624
    v_lshlrev_b32 v16, 16, v100
    v_and_b32 v17, 0xffff0000, v100
    v_lshlrev_b32 v18, 16, v101
    v_and_b32 v19, 0xffff0000, v101
    v_lshlrev_b32 v20, 16, v102
    v_and_b32 v21, 0xffff0000, v102
    v_lshlrev_b32 v22, 16, v103
    v_and_b32 v23, 0xffff0000, v103
    ds_write_b128 v62, v[16:19] offset:7168
    ds_write_b128 v62, v[20:23] offset:7184
    v_lshlrev_b32 v24, 16, v112
    v_and_b32 v25, 0xffff0000, v112
    v_lshlrev_b32 v26, 16, v113
    v_and_b32 v27, 0xffff0000, v113
    v_lshlrev_b32 v28, 16, v114
    v_and_b32 v29, 0xffff0000, v114
    v_lshlrev_b32 v30, 16, v115
    v_and_b32 v31, 0xffff0000, v115
    ds_write_b128 v62, v[24:27] offset:14848
    ds_write_b128 v62, v[28:31] offset:14864
    v_lshlrev_b32 v32, 16, v108
    v_and_b32 v33, 0xffff0000, v108
    v_lshlrev_b32 v34, 16, v109
    v_and_b32 v35, 0xffff0000, v109
    v_lshlrev_b32 v36, 16, v110
    v_and_b32 v37, 0xffff0000, v110
    v_lshlrev_b32 v38, 16, v111
    v_and_b32 v39, 0xffff0000, v111
    v_pk_add_f32 v[32:33], v[32:33], 1.0 op_sel_hi:[1,0]
    v_pk_add_f32 v[34:35], v[34:35], 1.0 op_sel_hi:[1,0]
    v_pk_add_f32 v[36:37], v[36:37], 1.0 op_sel_hi:[1,0]
    v_pk_add_f32 v[38:39], v[38:39], 1.0 op_sel_hi:[1,0]
    ds_write_b128 v62, v[32:35] offset:9728
    ds_write_b128 v62, v[36:39] offset:9744
    v_lshlrev_b32 v40, 16, v104
    v_and_b32 v41, 0xffff0000, v104
    v_lshlrev_b32 v42, 16, v105
    v_and_b32 v43, 0xffff0000, v105
    v_lshlrev_b32 v44, 16, v106
    v_and_b32 v45, 0xffff0000, v106
    v_lshlrev_b32 v46, 16, v107
    v_and_b32 v47, 0xffff0000, v107
    ds_write_b128 v62, v[40:43] offset:12288
    ds_write_b128 v62, v[44:47] offset:12304
    v_lshlrev_b32 v16, 16, v116
    v_and_b32 v17, 0xffff0000, v116
    v_lshlrev_b32 v18, 16, v117
    v_and_b32 v19, 0xffff0000, v117
    v_lshlrev_b32 v20, 16, v118
    v_and_b32 v21, 0xffff0000, v118
    v_lshlrev_b32 v22, 16, v119
    v_and_b32 v23, 0xffff0000, v119
    v_pk_mul_f32 v[24:25], v[32:33], v[16:17]
    v_pk_mul_f32 v[26:27], v[34:35], v[18:19]
    v_pk_mul_f32 v[28:29], v[36:37], v[20:21]
    v_pk_mul_f32 v[30:31], v[38:39], v[22:23]
    ds_write_b128 v62, v[24:27] offset:17408
    ds_write_b128 v62, v[28:31] offset:17424
    v_pk_fma_f32 v[50:51], v[40:41], v[16:17], v[50:51]
    v_pk_add_f32 v[48:49], v[48:49], v[24:25]
    v_pk_fma_f32 v[50:51], v[42:43], v[18:19], v[50:51]
    v_pk_add_f32 v[48:49], v[48:49], v[26:27]
    v_pk_fma_f32 v[50:51], v[44:45], v[20:21], v[50:51]
    v_pk_add_f32 v[48:49], v[48:49], v[28:29]
    v_pk_fma_f32 v[50:51], v[46:47], v[22:23], v[50:51]
    v_pk_add_f32 v[48:49], v[48:49], v[30:31]
    s_mov_b64 exec, -1
    v_add_f32 v48, v48, v49
    v_add_f32 v50, v50, v51
    v_lshrrev_b32 v49, 5, v1
    v_lshlrev_b32 v49, 2, v49
    v_permlane32_swap_b32 v48, v50
    v_add_f32 v48, v48, v50
    v_add_u32 v49, 161984, v49
    v_mov_b32 v50, v48
    s_nop 1
    v_permlane16_swap_b32 v48, v50
    v_add_f32 v48, v48, v50
    s_nop 1
    v_add_f32_dpp v48, v48, v48 row_ror:8 row_mask:0xf bank_mask:0xf
    s_nop 1
    v_add_f32_dpp v48, v48, v48 row_ror:4 row_mask:0xf bank_mask:0xf
    s_nop 1
    v_add_f32_dpp v48, v48, v48 row_ror:2 row_mask:0xf bank_mask:0xf
    s_nop 1
    v_add_f32_dpp v48, v48, v48 row_ror:1 row_mask:0xf bank_mask:0xf
    ds_write_b32 v49, v48
    v_mov_b32 v2, 162768
    v_mov_b32 v3, 4
    s_mov_b64 exec, 1
    ds_add_u32 v2, v3
    s_mov_b64 exec, -1
L_nc_ln1:
    s_waitcnt vmcnt(0)
    v_lshlrev_b32 v64, 16, v140
    v_and_b32 v65, 0xffff0000, v140
    v_lshlrev_b32 v66, 16, v141
    v_and_b32 v67, 0xffff0000, v141
    v_lshlrev_b32 v68, 16, v142
    v_and_b32 v69, 0xffff0000, v142
    v_lshlrev_b32 v70, 16, v143
    v_and_b32 v71, 0xffff0000, v143
    v_lshlrev_b32 v72, 16, v144
    v_and_b32 v73, 0xffff0000, v144
    v_lshlrev_b32 v74, 16, v145
    v_and_b32 v75, 0xffff0000, v145
    v_lshlrev_b32 v76, 16, v146
    v_and_b32 v77, 0xffff0000, v146
    v_lshlrev_b32 v78, 16, v147
    v_and_b32 v79, 0xffff0000, v147
    v_lshlrev_b32 v80, 16, v148
    v_and_b32 v81, 0xffff0000, v148
    v_lshlrev_b32 v82, 16, v149
    v_and_b32 v83, 0xffff0000, v149
    v_pk_add_f32 v[84:85], v[64:65], v[66:67]
    v_pk_mul_f32 v[86:87], v[64:65], v[64:65]
    v_pk_fma_f32 v[86:87], v[66:67], v[66:67], v[86:87]
    v_pk_add_f32 v[84:85], v[84:85], v[68:69]
    v_pk_fma_f32 v[86:87], v[68:69], v[68:69], v[86:87]
    v_pk_add_f32 v[84:85], v[84:85], v[70:71]
    v_pk_fma_f32 v[86:87], v[70:71], v[70:71], v[86:87]
    v_pk_add_f32 v[84:85], v[84:85], v[72:73]
    v_pk_fma_f32 v[86:87], v[72:73], v[72:73], v[86:87]
    v_pk_add_f32 v[84:85], v[84:85], v[74:75]
    v_pk_fma_f32 v[86:87], v[74:75], v[74:75], v[86:87]
    v_pk_add_f32 v[84:85], v[84:85], v[76:77]
    v_pk_fma_f32 v[86:87], v[76:77], v[76:77], v[86:87]
    v_pk_add_f32 v[84:85], v[84:85], v[78:79]
    v_pk_fma_f32 v[86:87], v[78:79], v[78:79], v[86:87]
    v_pk_add_f32 v[84:85], v[84:85], v[80:81]
    v_pk_fma_f32 v[86:87], v[80:81], v[80:81], v[86:87]
    v_pk_add_f32 v[84:85], v[84:85], v[82:83]
    v_pk_fma_f32 v[86:87], v[82:83], v[82:83], v[86:87]
    v_add_f32 v84, v84, v85
    v_add_f32 v86, v86, v87
    s_nop 1
    v_permlane32_swap_b32 v84, v86
    v_add_f32 v84, v84, v86
    v_mov_b32 v86, v84
    s_nop 1
    v_permlane16_swap_b32 v84, v86
    v_add_f32 v84, v84, v86
    s_nop 1
    v_add_f32_dpp v84, v84, v84 row_ror:8 row_mask:0xf bank_mask:0xf
    ds_write_b32 v150, v84 offset:0
    v_mov_b32 v2, 162760
    v_mov_b32 v3, 1
    s_mov_b64 exec, 1
    ds_add_u32 v2, v3
    s_mov_b64 exec, -1
    v_mov_b32 v2, 162760
    s_mov_b32 s15, 0
L_lw_23:
    ds_read_b32 v3, v2
    s_waitcnt lgkmcnt(0)
    v_cmp_gt_u32 vcc, 4, v3
    s_cbranch_vccz L_lwd_24
    s_sleep 2
    s_add_u32 s15, s15, 1
    s_cmp_lt_u32 s15, 1600000
    s_cbranch_scc1 L_lw_23
L_lwd_24:
    v_mov_b32 v2, 162768
    s_mov_b32 s15, 0
L_lw_25:
    ds_read_b32 v3, v2
    s_waitcnt lgkmcnt(0)
    v_cmp_gt_u32 vcc, 4, v3
    s_cbranch_vccz L_lwd_26
    s_sleep 2
    s_add_u32 s15, s15, 1
    s_cmp_lt_u32 s15, 1600000
    s_cbranch_scc1 L_lw_25
L_lwd_26:
    s_branch L_row
L_nc_w4:
    s_cmp_ge_u32 s7, 94
    s_cbranch_scc1 L_row_w4
    s_sleep 0
L_nc_w4_go:
    s_cmp_ge_u32 s7, 54
    s_cbranch_scc1 L_nc_w4_down
    s_and_b32 s10, s7, 7
    s_lshr_b32 s11, s7, 3
    s_mul_i32 s14, s10, 7
    s_add_u32 s14, s14, s11
    s_cmp_eq_u32 s10, 7
    s_cselect_b32 s10, 1, 0
    s_sub_u32 s14, s14, s10
    s_mov_b32 s72, s32
    s_mov_b32 s73, s33
    s_mov_b32 s74, 2211840
    s_mov_b32 s75, 0x20000
    s_mov_b32 s76, s34
    s_mov_b32 s77, s35
    s_mov_b32 s78, 2211840
    s_mov_b32 s79, 0x20000
    v_lshrrev_b32 v2, 2, v1
    v_mul_u32_u24 v2, 3456, v2
    v_and_b32 v3, 3, v1
    v_lshl_add_u32 v2, v3, 4, v2
    s_lshl_b32 s14, s14, 6
    v_add_u32 v2, s14, v2
    s_mov_b32 s10, 0
    s_mov_b32 s11, 0
L_gu_dma:
    s_mov_b32 m0, s11
    s_add_u32 s12, s11, 40960
    buffer_load_dwordx4 v2, s[72:75], s10 offen lds
    s_mov_b32 m0, s12
    s_add_u32 s11, s11, 1024
    buffer_load_dwordx4 v2, s[76:79], s10 offen lds
    s_add_u32 s10, s10, 55296
    s_waitcnt vmcnt(40)
    s_cmp_lt_u32 s11, 40960
    s_cbranch_scc1 L_gu_dma
    s_branch L_row_w4
L_nc_w4_down:
    s_sub_u32 s10, s7, 54
    s_and_b32 s11, s10, 7
    s_lshr_b32 s10, s10, 3
    s_mul_i32 s14, s11, 5
    s_add_u32 s14, s14, s10
    s_mov_b32 s72, s36
    s_mov_b32 s73, s37
    s_mov_b32 s74, 2211840
    s_mov_b32 s75, 0x20000
    v_lshrrev_b32 v2, 1, v1
    v_mul_u32_u24 v2, 1280, v2
    v_and_b32 v3, 1, v1
    v_lshl_add_u32 v2, v3, 4, v2
    s_lshl_b32 s14, s14, 5
    v_add_u32 v2, s14, v2
    s_mov_b32 s10, 0
    s_mov_b32 s11, 0
L_dn_dma:
    s_mov_b32 m0, s11
    s_add_u32 s11, s11, 1024
    buffer_load_dwordx4 v2, s[72:75], s10 offen lds
    s_add_u32 s10, s10, 40960
    s_waitcnt vmcnt(40)
    s_cmp_lt_u32 s11, 55296
    s_cbranch_scc1 L_dn_dma
    s_branch L_row_w4
L_row:
    s_mul_i32 s10, s8, 10240
    s_mul_i32 s11, s3, 2560
    s_add_u32 s10, s10, s11
    s_add_u32 s10, s10, 5242880
    v_lshlrev_b32 v224, 4, v1
    v_add_u32 v222, s10, v224
    v_add_u32 v223, 2048, v222
    v_mov_b32 v225, 2147483648
    v_cmp_gt_u32 vcc, 32, v1
    s_nop 1
    v_cndmask_b32 v223, v225, v223, vcc
    s_mul_i32 s10, s3, 3072
    s_add_u32 s10, s10, 84992
    v_add_u32 v224, s10, v224
    v_lshrrev_b32 v225, 4, v1
    v_lshlrev_b32 v225, 7, v225
    v_and_b32 v226, 2, v1
    v_lshl_add_u32 v225, v226, 5, v225
    v_and_b32 v226, 12, v1
    v_lshl_add_u32 v225, v226, 2, v225
    v_and_b32 v226, 1, v1
    v_lshl_add_u32 v225, v226, 3, v225
    v_add_u32 v225, s10, v225
    s_cmp_eq_u32 s9, 0
    s_cbranch_scc1 L_noearly
    buffer_load_dwordx4 v[228:231], v222, s[56:59], 0 offen sc1
    buffer_load_dwordx4 v[232:235], v222, s[56:59], 0 offen offset:1024 sc1
    buffer_load_dwordx4 v[236:239], v223, s[56:59], 0 offen sc1
L_noearly:
    v_lshlrev_b32 v135, 1, v132
    v_add_u32 v135, 140064, v135
    ds_read_b128 v[152:155], v135 offset:0
    ds_read_b128 v[156:159], v135 offset:128
    ds_read_b128 v[160:163], v135 offset:256
    ds_read_b128 v[164:167], v135 offset:384
    ds_read_b128 v[168:171], v135 offset:512
    ds_read_b128 v[172:175], v135 offset:2560
    ds_read_b128 v[176:179], v135 offset:2688
    ds_read_b128 v[180:183], v135 offset:2816
    ds_read_b128 v[184:187], v135 offset:2944
    ds_read_b128 v[188:191], v135 offset:3072
    s_waitcnt lgkmcnt(5)
    ds_read_b128 v[192:195], v135 offset:5120
    ds_read_b128 v[196:199], v135 offset:5248
    ds_read_b128 v[200:203], v135 offset:5376
    ds_read_b128 v[204:207], v135 offset:5504
    ds_read_b128 v[208:211], v135 offset:5632
    v_lshlrev_b32 v2, 16, v140
    v_and_b32 v3, 0xffff0000, v140
    v_lshlrev_b32 v4, 16, v141
    v_and_b32 v5, 0xffff0000, v141
    v_lshlrev_b32 v6, 16, v142
    v_and_b32 v7, 0xffff0000, v142
    v_lshlrev_b32 v8, 16, v143
    v_and_b32 v9, 0xffff0000, v143
    v_lshlrev_b32 v10, 16, v144
    v_and_b32 v11, 0xffff0000, v144
    v_lshlrev_b32 v12, 16, v145
    v_and_b32 v13, 0xffff0000, v145
    v_lshlrev_b32 v14, 16, v146
    v_and_b32 v15, 0xffff0000, v146
    v_lshlrev_b32 v16, 16, v147
    v_and_b32 v17, 0xffff0000, v147
    v_lshlrev_b32 v18, 16, v148
    v_and_b32 v19, 0xffff0000, v148
    v_lshlrev_b32 v20, 16, v149
    v_and_b32 v21, 0xffff0000, v149
    ds_read_b128 v[240:243], v151 offset:0
    ds_read_b128 v[244:247], v151 offset:16
    s_mov_b32 s10, 0x3acccccd
    s_waitcnt lgkmcnt(0)
    v_pk_add_f32 v[240:241], v[240:241], v[242:243]
    v_pk_add_f32 v[244:245], v[244:245], v[246:247]
    v_pk_add_f32 v[240:241], v[240:241], v[244:245]
    v_mul_f32 v240, s10, v240
    v_mul_f32 v241, s10, v241
    v_fma_f32 v241, -v240, v240, v241
    v_max_f32 v241, 0, v241
    v_cvt_pk_bf16_f32 v242, v240, v241
    v_and_b32 v241, 0xffff0000, v242
    v_lshlrev_b32 v240, 16, v242
    v_add_f32 v241, 0x3727c5ac, v241
    v_cvt_pk_bf16_f32 v241, v241, v241
    v_lshlrev_b32 v241, 16, v241
    v_sqrt_f32 v241, v241
    s_nop 0
    v_cvt_pk_bf16_f32 v241, v241, v241
    v_lshlrev_b32 v241, 16, v241
    v_rcp_f32 v248, v241
    s_nop 0
    v_mul_f32 v249, v240, v248
    v_sub_f32 v249, 0, v249
    ds_read_b128 v[44:47], v135 offset:7680
    ds_read_b128 v[48:51], v135 offset:7808
    ds_read_b128 v[52:55], v135 offset:7936
    ds_read_b128 v[56:59], v135 offset:8064
    ds_read_b128 v[60:63], v135 offset:8192
    ds_read_b128 v[64:67], v135 offset:10240
    ds_read_b128 v[68:71], v135 offset:10368
    ds_read_b128 v[72:75], v135 offset:10496
    ds_read_b128 v[76:79], v135 offset:10624
    ds_read_b128 v[80:83], v135 offset:10752
    v_pk_fma_f32 v[22:23], v[2:3], v[248:249], v[248:249] op_sel:[0,0,1] op_sel_hi:[1,0,1]
    v_pk_fma_f32 v[24:25], v[4:5], v[248:249], v[248:249] op_sel:[0,0,1] op_sel_hi:[1,0,1]
    v_pk_fma_f32 v[26:27], v[6:7], v[248:249], v[248:249] op_sel:[0,0,1] op_sel_hi:[1,0,1]
    v_pk_fma_f32 v[28:29], v[8:9], v[248:249], v[248:249] op_sel:[0,0,1] op_sel_hi:[1,0,1]
    v_pk_fma_f32 v[30:31], v[10:11], v[248:249], v[248:249] op_sel:[0,0,1] op_sel_hi:[1,0,1]
    v_pk_fma_f32 v[32:33], v[12:13], v[248:249], v[248:249] op_sel:[0,0,1] op_sel_hi:[1,0,1]
    v_pk_fma_f32 v[34:35], v[14:15], v[248:249], v[248:249] op_sel:[0,0,1] op_sel_hi:[1,0,1]
    v_pk_fma_f32 v[36:37], v[16:17], v[248:249], v[248:249] op_sel:[0,0,1] op_sel_hi:[1,0,1]
    v_pk_fma_f32 v[38:39], v[18:19], v[248:249], v[248:249] op_sel:[0,0,1] op_sel_hi:[1,0,1]
    v_pk_fma_f32 v[40:41], v[20:21], v[248:249], v[248:249] op_sel:[0,0,1] op_sel_hi:[1,0,1]
    s_waitcnt lgkmcnt(5)
    ds_read_b128 v[84:87], v135 offset:12800
    ds_read_b128 v[88:91], v135 offset:12928
    ds_read_b128 v[92:95], v135 offset:13056
    ds_read_b128 v[96:99], v135 offset:13184
    ds_read_b128 v[100:103], v135 offset:13312
    ds_read_b128 v[104:107], v135 offset:15360
    ds_read_b128 v[108:111], v135 offset:15488
    ds_read_b128 v[112:115], v135 offset:15616
    ds_read_b128 v[116:119], v135 offset:15744
    ds_read_b128 v[120:123], v135 offset:15872
    v_pk_fma_f32 v[22:23], v[22:23], v[152:153], v[172:173]
    v_pk_fma_f32 v[24:25], v[24:25], v[154:155], v[174:175]
    v_pk_fma_f32 v[26:27], v[26:27], v[156:157], v[176:177]
    v_pk_fma_f32 v[28:29], v[28:29], v[158:159], v[178:179]
    v_pk_fma_f32 v[30:31], v[30:31], v[160:161], v[180:181]
    v_pk_fma_f32 v[32:33], v[32:33], v[162:163], v[182:183]
    v_pk_fma_f32 v[34:35], v[34:35], v[164:165], v[184:185]
    v_pk_fma_f32 v[36:37], v[36:37], v[166:167], v[186:187]
    v_pk_fma_f32 v[38:39], v[38:39], v[168:169], v[188:189]
    v_pk_fma_f32 v[40:41], v[40:41], v[170:171], v[190:191]
    v_pk_mul_f32 v[22:23], v[22:23], v[192:193]
    v_pk_mul_f32 v[24:25], v[24:25], v[194:195]
    v_pk_mul_f32 v[26:27], v[26:27], v[196:197]
    v_pk_mul_f32 v[28:29], v[28:29], v[198:199]
    v_pk_mul_f32 v[30:31], v[30:31], v[200:201]
    v_pk_mul_f32 v[32:33], v[32:33], v[202:203]
    v_pk_mul_f32 v[34:35], v[34:35], v[204:205]
    v_pk_mul_f32 v[36:37], v[36:37], v[206:207]
    v_pk_mul_f32 v[38:39], v[38:39], v[208:209]
    v_pk_mul_f32 v[40:41], v[40:41], v[210:211]
    v_mov_b32 v227, 161984
    ds_read_b64 v[250:251], v227
    v_lshrrev_b32 v240, 4, v1
    v_lshrrev_b32 v241, 1, v240
    v_and_b32 v240, 1, v240
    v_lshlrev_b32 v240, 1, v240
    v_max_u32 v240, v240, v241
    v_min_u32 v240, 2, v240
    v_mul_u32_u24 v151, 48, v133
    v_add_u32 v151, 161472, v151
    v_lshl_add_u32 v150, v240, 4, v151
    s_lshl_b32 s10, s3, 2
    v_add_u32 v150, s10, v150
    s_lshl_b32 s10, s8, 3
    s_sub_u32 s10, 2047, s10
    v_sub_u32 v254, s10, v133
    s_lshl_b32 s10, s8, 6
    s_add_u32 s10, s10, 36864
    v_mov_b32 v255, s10
    s_mov_b32 s15, 0
    s_cmp_eq_u32 s9, 0
    s_cbranch_scc1 L_inld
L_in_27:
    s_waitcnt vmcnt(0)
    v_max3_u32 v226, v228, v229, v230
    v_max3_u32 v226, v226, v231, v232
    v_max3_u32 v226, v226, v233, v234
    v_max3_u32 v226, v226, v235, v236
    v_max3_u32 v226, v226, v237, v238
    v_max_u32 v226, v226, v239
    v_cmp_eq_u32 vcc, -1, v226
    s_cbranch_vccz L_ind_28
    s_sleep 4
    s_add_u32 s15, s15, 1
    s_cmp_ge_u32 s15, 200000
    s_cbranch_scc1 L_ind_28
L_inld:
    buffer_load_dwordx4 v[228:231], v222, s[56:59], 0 offen sc1
    buffer_load_dwordx4 v[232:235], v222, s[56:59], 0 offen offset:1024 sc1
    buffer_load_dwordx4 v[236:239], v223, s[56:59], 0 offen sc1
    s_branch L_in_27
L_ind_28:
    ds_write_b128 v224, v[228:231] offset:0
    ds_write_b128 v224, v[232:235] offset:1024
    ds_write_b128 v224, v[236:239] offset:2048
    s_waitcnt lgkmcnt(0)
    ds_read_b64_tr_b16 v[152:153], v225 offset:0
    ds_read_b64_tr_b16 v[154:155], v225 offset:512
    ds_read_b64_tr_b16 v[156:157], v225 offset:1024
    ds_read_b64_tr_b16 v[158:159], v225 offset:1536
    ds_read_b64_tr_b16 v[160:161], v225 offset:2048
    s_waitcnt lgkmcnt(4)
    v_lshlrev_b32 v192, 16, v152
    v_and_b32 v193, 0xffff0000, v152
    v_pk_fma_f32 v[162:163], v[22:23], v[192:193], v[2:3]
    v_lshlrev_b32 v194, 16, v153
    v_and_b32 v195, 0xffff0000, v153
    v_pk_fma_f32 v[164:165], v[24:25], v[194:195], v[4:5]
    v_pk_add_f32 v[240:241], v[162:163], v[164:165]
    v_pk_mul_f32 v[242:243], v[162:163], v[162:163]
    v_pk_mul_f32 v[244:245], v[162:163], v[104:105]
    v_pk_fma_f32 v[242:243], v[164:165], v[164:165], v[242:243]
    v_pk_fma_f32 v[244:245], v[164:165], v[106:107], v[244:245]
    s_waitcnt lgkmcnt(3)
    v_lshlrev_b32 v196, 16, v154
    v_and_b32 v197, 0xffff0000, v154
    v_pk_fma_f32 v[166:167], v[26:27], v[196:197], v[6:7]
    v_pk_add_f32 v[240:241], v[240:241], v[166:167]
    v_pk_fma_f32 v[242:243], v[166:167], v[166:167], v[242:243]
    v_pk_fma_f32 v[244:245], v[166:167], v[108:109], v[244:245]
    v_lshlrev_b32 v198, 16, v155
    v_and_b32 v199, 0xffff0000, v155
    v_pk_fma_f32 v[168:169], v[28:29], v[198:199], v[8:9]
    v_pk_add_f32 v[240:241], v[240:241], v[168:169]
    v_pk_fma_f32 v[242:243], v[168:169], v[168:169], v[242:243]
    v_pk_fma_f32 v[244:245], v[168:169], v[110:111], v[244:245]
    s_waitcnt lgkmcnt(2)
    v_lshlrev_b32 v200, 16, v156
    v_and_b32 v201, 0xffff0000, v156
    v_pk_fma_f32 v[170:171], v[30:31], v[200:201], v[10:11]
    v_pk_add_f32 v[240:241], v[240:241], v[170:171]
    v_pk_fma_f32 v[242:243], v[170:171], v[170:171], v[242:243]
    v_pk_fma_f32 v[244:245], v[170:171], v[112:113], v[244:245]
    v_lshlrev_b32 v202, 16, v157
    v_and_b32 v203, 0xffff0000, v157
    v_pk_fma_f32 v[172:173], v[32:33], v[202:203], v[12:13]
    v_pk_add_f32 v[240:241], v[240:241], v[172:173]
    v_pk_fma_f32 v[242:243], v[172:173], v[172:173], v[242:243]
    v_pk_fma_f32 v[244:245], v[172:173], v[114:115], v[244:245]
    s_waitcnt lgkmcnt(1)
    v_lshlrev_b32 v204, 16, v158
    v_and_b32 v205, 0xffff0000, v158
    v_pk_fma_f32 v[174:175], v[34:35], v[204:205], v[14:15]
    v_pk_add_f32 v[240:241], v[240:241], v[174:175]
    v_pk_fma_f32 v[242:243], v[174:175], v[174:175], v[242:243]
    v_pk_fma_f32 v[244:245], v[174:175], v[116:117], v[244:245]
    v_lshlrev_b32 v206, 16, v159
    v_and_b32 v207, 0xffff0000, v159
    v_pk_fma_f32 v[176:177], v[36:37], v[206:207], v[16:17]
    v_pk_add_f32 v[240:241], v[240:241], v[176:177]
    v_pk_fma_f32 v[242:243], v[176:177], v[176:177], v[242:243]
    v_pk_fma_f32 v[244:245], v[176:177], v[118:119], v[244:245]
    s_waitcnt lgkmcnt(0)
    v_lshlrev_b32 v208, 16, v160
    v_and_b32 v209, 0xffff0000, v160
    v_pk_fma_f32 v[178:179], v[38:39], v[208:209], v[18:19]
    v_pk_add_f32 v[240:241], v[240:241], v[178:179]
    v_pk_fma_f32 v[242:243], v[178:179], v[178:179], v[242:243]
    v_pk_fma_f32 v[244:245], v[178:179], v[120:121], v[244:245]
    v_lshlrev_b32 v210, 16, v161
    v_and_b32 v211, 0xffff0000, v161
    v_pk_fma_f32 v[180:181], v[40:41], v[210:211], v[20:21]
    v_pk_add_f32 v[240:241], v[240:241], v[180:181]
    v_pk_fma_f32 v[242:243], v[180:181], v[180:181], v[242:243]
    v_pk_fma_f32 v[244:245], v[180:181], v[122:123], v[244:245]
    v_add_f32 v240, v240, v241
    v_add_f32 v242, v242, v243
    v_add_f32 v244, v244, v245
    s_nop 0
    v_permlane32_swap_b32 v240, v242
    v_mov_b32 v245, v244
    v_add_f32 v240, v240, v242
    s_nop 0
    v_permlane32_swap_b32 v244, v245
    v_add_f32 v244, v244, v245
    s_nop 1
    v_permlane16_swap_b32 v240, v244
    v_add_f32 v240, v240, v244
    s_nop 1
    v_add_f32_dpp v240, v240, v240 row_ror:8 row_mask:0xf bank_mask:0xf
    ds_write_b32 v150, v240
    s_waitcnt lgkmcnt(0)
    s_barrier
    ds_read_b128 v[228:231], v151
    ds_read_b128 v[232:235], v151 offset:16
    ds_read_b128 v[236:239], v151 offset:32
    s_mov_b32 s10, 0x3acccccd
    s_waitcnt lgkmcnt(1)
    v_pk_add_f32 v[228:229], v[228:229], v[230:231]
    v_pk_add_f32 v[232:233], v[232:233], v[234:235]
    v_add_f32 v228, v228, v229
    v_add_f32 v229, v232, v233
    v_mul_f32 v228, s10, v228
    v_mul_f32 v229, s10, v229
    v_fma_f32 v229, -v228, v228, v229
    v_max_f32 v229, 0, v229
    v_cvt_pk_bf16_f32 v230, v228, v229
    v_and_b32 v229, 0xffff0000, v230
    v_lshlrev_b32 v228, 16, v230
    v_add_f32 v229, 0x3727c5ac, v229
    v_cvt_pk_bf16_f32 v229, v229, v229
    s_waitcnt lgkmcnt(0)
    v_pk_add_f32 v[236:237], v[236:237], v[238:239]
    v_lshlrev_b32 v229, 16, v229
    v_sqrt_f32 v229, v229
    v_add_f32 v236, v236, v237
    v_cvt_pk_bf16_f32 v229, v229, v229
    v_fma_f32 v236, -v228, v250, v236
    v_lshlrev_b32 v229, 16, v229
    v_rcp_f32 v248, v229
    s_nop 0
    v_mul_f32 v249, v228, v248
    v_fma_f32 v240, v236, v248, v251
    v_sub_f32 v249, 0, v249
    v_cvt_pk_bf16_f32 v240, v240, v240
    v_ashrrev_i32 v242, 31, v240
    v_or_b32 v242, 0x80000000, v242
    v_xor_b32 v240, v240, v242
    v_and_b32 v240, 0xffff0000, v240
    v_or_b32 v240, v240, v254
    s_nop 1
    v_max_u32_dpp v244, v240, v240 quad_perm:[1,0,3,2] row_mask:0xf bank_mask:0xf
    s_nop 1
    v_max_u32_dpp v244, v244, v244 quad_perm:[2,3,0,1] row_mask:0xf bank_mask:0xf
    s_nop 1
    v_max_u32_dpp v244, v244, v244 row_half_mirror row_mask:0xf bank_mask:0xf
    v_cmp_eq_u32 s[12:13], v240, v244
    s_nop 1
    v_cndmask_b32 v242, v240, 0, s[12:13]
    s_nop 1
    v_max_u32_dpp v245, v242, v242 quad_perm:[1,0,3,2] row_mask:0xf bank_mask:0xf
    s_nop 1
    v_max_u32_dpp v245, v245, v245 quad_perm:[2,3,0,1] row_mask:0xf bank_mask:0xf
    s_nop 1
    v_max_u32_dpp v245, v245, v245 row_half_mirror row_mask:0xf bank_mask:0xf
    s_mov_b64 s[80:81], exec
    s_cmp_lg_u32 s3, 0
    s_cbranch_scc1 L_nogran
    s_mov_b64 exec, 1
    buffer_store_dwordx2 v[244:245], v255, s[56:59], 0 offen sc1
    s_mov_b64 exec, s[80:81]
L_nogran:
    v_cmp_eq_u32 vcc, v240, v245
    s_mul_i32 s10, s8, 2560
    v_add_u32 v247, s10, v132
    v_add_u32 v241, 1280, v247
    v_cndmask_b32 v247, v247, v241, vcc
    s_or_b64 s[12:13], s[12:13], vcc
    v_pk_fma_f32 v[192:193], v[162:163], v[248:249], v[248:249] op_sel:[0,0,1] op_sel_hi:[1,0,1]
    v_pk_fma_f32 v[194:195], v[164:165], v[248:249], v[248:249] op_sel:[0,0,1] op_sel_hi:[1,0,1]
    v_pk_fma_f32 v[196:197], v[166:167], v[248:249], v[248:249] op_sel:[0,0,1] op_sel_hi:[1,0,1]
    v_pk_fma_f32 v[198:199], v[168:169], v[248:249], v[248:249] op_sel:[0,0,1] op_sel_hi:[1,0,1]
    v_pk_fma_f32 v[200:201], v[170:171], v[248:249], v[248:249] op_sel:[0,0,1] op_sel_hi:[1,0,1]
    v_pk_fma_f32 v[202:203], v[172:173], v[248:249], v[248:249] op_sel:[0,0,1] op_sel_hi:[1,0,1]
    v_pk_fma_f32 v[204:205], v[174:175], v[248:249], v[248:249] op_sel:[0,0,1] op_sel_hi:[1,0,1]
    v_pk_fma_f32 v[206:207], v[176:177], v[248:249], v[248:249] op_sel:[0,0,1] op_sel_hi:[1,0,1]
    v_pk_fma_f32 v[208:209], v[178:179], v[248:249], v[248:249] op_sel:[0,0,1] op_sel_hi:[1,0,1]
    v_pk_fma_f32 v[210:211], v[180:181], v[248:249], v[248:249] op_sel:[0,0,1] op_sel_hi:[1,0,1]
    v_pk_fma_f32 v[192:193], v[192:193], v[44:45], v[64:65]
    v_pk_fma_f32 v[194:195], v[194:195], v[46:47], v[66:67]
    v_pk_fma_f32 v[196:197], v[196:197], v[48:49], v[68:69]
    v_pk_fma_f32 v[198:199], v[198:199], v[50:51], v[70:71]
    v_pk_fma_f32 v[200:201], v[200:201], v[52:53], v[72:73]
    v_pk_fma_f32 v[202:203], v[202:203], v[54:55], v[74:75]
    v_pk_fma_f32 v[204:205], v[204:205], v[56:57], v[76:77]
    v_pk_fma_f32 v[206:207], v[206:207], v[58:59], v[78:79]
    v_pk_fma_f32 v[208:209], v[208:209], v[60:61], v[80:81]
    v_pk_fma_f32 v[210:211], v[210:211], v[62:63], v[82:83]
    v_cvt_pk_bf16_f32 v212, v192, v193
    v_cvt_pk_bf16_f32 v213, v194, v195
    v_cvt_pk_bf16_f32 v214, v196, v197
    v_cvt_pk_bf16_f32 v215, v198, v199
    v_cvt_pk_bf16_f32 v216, v200, v201
    v_cvt_pk_bf16_f32 v217, v202, v203
    v_cvt_pk_bf16_f32 v218, v204, v205
    v_cvt_pk_bf16_f32 v219, v206, v207
    v_cvt_pk_bf16_f32 v220, v208, v209
    v_cvt_pk_bf16_f32 v221, v210, v211
    s_mov_b64 exec, s[12:13]
    s_mov_b32 s10, 131072
    buffer_store_dwordx2 v[212:213], v247, s[56:59], s10 offen offset:0 sc1
    buffer_store_dwordx2 v[214:215], v247, s[56:59], s10 offen offset:64 sc1
    buffer_store_dwordx2 v[216:217], v247, s[56:59], s10 offen offset:128 sc1
    buffer_store_dwordx2 v[218:219], v247, s[56:59], s10 offen offset:192 sc1
    buffer_store_dwordx2 v[220:221], v247, s[56:59], s10 offen offset:256 sc1
    v_cvt_pk_bf16_f32 v182, v162, v163
    v_cvt_pk_bf16_f32 v183, v164, v165
    v_cvt_pk_bf16_f32 v184, v166, v167
    v_cvt_pk_bf16_f32 v185, v168, v169
    v_cvt_pk_bf16_f32 v186, v170, v171
    v_cvt_pk_bf16_f32 v187, v172, v173
    v_cvt_pk_bf16_f32 v188, v174, v175
    v_cvt_pk_bf16_f32 v189, v176, v177
    v_cvt_pk_bf16_f32 v190, v178, v179
    v_cvt_pk_bf16_f32 v191, v180, v181
    s_mov_b32 s10, 786432
    buffer_store_dwordx2 v[182:183], v247, s[56:59], s10 offen offset:0 sc1
    buffer_store_dwordx2 v[184:185], v247, s[56:59], s10 offen offset:64 sc1
    buffer_store_dwordx2 v[186:187], v247, s[56:59], s10 offen offset:128 sc1
    buffer_store_dwordx2 v[188:189], v247, s[56:59], s10 offen offset:192 sc1
    buffer_store_dwordx2 v[190:191], v247, s[56:59], s10 offen offset:256 sc1
    s_mov_b64 exec, s[80:81]
    v_pk_fma_f32 v[162:163], v[84:85], v[192:193], v[162:163]
    v_pk_fma_f32 v[164:165], v[86:87], v[194:195], v[164:165]
    v_pk_fma_f32 v[166:167], v[88:89], v[196:197], v[166:167]
    v_pk_fma_f32 v[168:169], v[90:91], v[198:199], v[168:169]
    v_pk_fma_f32 v[170:171], v[92:93], v[200:201], v[170:171]
    v_pk_fma_f32 v[172:173], v[94:95], v[202:203], v[172:173]
    v_pk_fma_f32 v[174:175], v[96:97], v[204:205], v[174:175]
    v_pk_fma_f32 v[176:177], v[98:99], v[206:207], v[176:177]
    v_pk_fma_f32 v[178:179], v[100:101], v[208:209], v[178:179]
    v_pk_fma_f32 v[180:181], v[102:103], v[210:211], v[180:181]
    v_cvt_pk_bf16_f32 v152, v162, v163
    v_cvt_pk_bf16_f32 v153, v164, v165
    v_cvt_pk_bf16_f32 v154, v166, v167
    v_cvt_pk_bf16_f32 v155, v168, v169
    v_cvt_pk_bf16_f32 v156, v170, v171
    v_cvt_pk_bf16_f32 v157, v172, v173
    v_cvt_pk_bf16_f32 v158, v174, v175
    v_cvt_pk_bf16_f32 v159, v176, v177
    v_cvt_pk_bf16_f32 v160, v178, v179
    v_cvt_pk_bf16_f32 v161, v180, v181
    buffer_store_dwordx2 v[152:153], v131, s[64:67], 0 offen offset:0 sc1
    buffer_store_dwordx2 v[154:155], v131, s[64:67], 0 offen offset:64 sc1
    buffer_store_dwordx2 v[156:157], v131, s[64:67], 0 offen offset:128 sc1
    buffer_store_dwordx2 v[158:159], v131, s[64:67], 0 offen offset:192 sc1
    buffer_store_dwordx2 v[160:161], v131, s[64:67], 0 offen offset:256 sc1
    s_cmp_eq_u32 s9, 1
    s_cbranch_scc1 L_row_end
    s_cmp_ge_u32 s7, 94
    s_cbranch_scc1 L_row_end
    s_cmp_ge_u32 s7, 54
    s_cbranch_scc1 L_down
    v_lshrrev_b32 v2, 4, v1
    v_lshlrev_b32 v2, 3, v2
    v_bfe_u32 v3, v1, 2, 2
    v_add_u32 v2, v2, v3
    s_mul_i32 s10, s3, 160
    v_add_u32 v2, s10, v2
    v_lshlrev_b32 v2, 6, v2
    v_and_b32 v3, 3, v1
    v_lshl_add_u32 v2, v3, 3, v2
    ds_read_b64_tr_b16 v[16:17], v2 offset:0
    ds_read_b64_tr_b16 v[18:19], v2 offset:256
    ds_read_b64_tr_b16 v[20:21], v2 offset:32
    ds_read_b64_tr_b16 v[22:23], v2 offset:288
    ds_read_b64_tr_b16 v[24:25], v2 offset:40960
    ds_read_b64_tr_b16 v[26:27], v2 offset:41216
    ds_read_b64_tr_b16 v[28:29], v2 offset:40992
    ds_read_b64_tr_b16 v[30:31], v2 offset:41248
    ds_read_b64_tr_b16 v[32:33], v2 offset:2048
    ds_read_b64_tr_b16 v[34:35], v2 offset:2304
    ds_read_b64_tr_b16 v[36:37], v2 offset:2080
    ds_read_b64_tr_b16 v[38:39], v2 offset:2336
    ds_read_b64_tr_b16 v[40:41], v2 offset:43008
    ds_read_b64_tr_b16 v[42:43], v2 offset:43264
    ds_read_b64_tr_b16 v[44:45], v2 offset:43040
    ds_read_b64_tr_b16 v[46:47], v2 offset:43296
    ds_read_b64_tr_b16 v[48:49], v2 offset:4096
    ds_read_b64_tr_b16 v[50:51], v2 offset:4352
    ds_read_b64_tr_b16 v[52:53], v2 offset:4128
    ds_read_b64_tr_b16 v[54:55], v2 offset:4384
    ds_read_b64_tr_b16 v[56:57], v2 offset:45056
    ds_read_b64_tr_b16 v[58:59], v2 offset:45312
    ds_read_b64_tr_b16 v[60:61], v2 offset:45088
    ds_read_b64_tr_b16 v[62:63], v2 offset:45344
    ds_read_b64_tr_b16 v[64:65], v2 offset:6144
    ds_read_b64_tr_b16 v[66:67], v2 offset:6400
    ds_read_b64_tr_b16 v[68:69], v2 offset:6176
    ds_read_b64_tr_b16 v[70:71], v2 offset:6432
    ds_read_b64_tr_b16 v[72:73], v2 offset:47104
    ds_read_b64_tr_b16 v[74:75], v2 offset:47360
    ds_read_b64_tr_b16 v[76:77], v2 offset:47136
    ds_read_b64_tr_b16 v[78:79], v2 offset:47392
    ds_read_b64_tr_b16 v[80:81], v2 offset:8192
    ds_read_b64_tr_b16 v[82:83], v2 offset:8448
    ds_read_b64_tr_b16 v[84:85], v2 offset:8224
    ds_read_b64_tr_b16 v[86:87], v2 offset:8480
    ds_read_b64_tr_b16 v[88:89], v2 offset:49152
    ds_read_b64_tr_b16 v[90:91], v2 offset:49408
    ds_read_b64_tr_b16 v[92:93], v2 offset:49184
    ds_read_b64_tr_b16 v[94:95], v2 offset:49440
    v_mov_b32 v240, 162756
    v_mov_b32 v241, 1
    s_lshl_b32 s10, s8, 6
    s_add_u32 s10, s10, 20480
    v_mov_b32 v242, s10
    s_waitcnt vmcnt(0)
    s_mov_b64 s[12:13], exec
    s_mov_b64 exec, 1
    ds_add_rtn_u32 v243, v240, v241
    s_waitcnt lgkmcnt(0)
    v_cmp_eq_u32 vcc, 3, v243
    s_cbranch_vccz L_f2_29
    buffer_store_dword v139, v242, s[56:59], 0 offen sc1
L_f2_29:
    s_mov_b64 exec, s[12:13]
    v_and_b32 v3, 1, v1
    v_lshlrev_b32 v3, 2, v3
    v_add_u32 v3, 162240, v3
    v_lshrrev_b32 v4, 4, v1
    v_lshlrev_b32 v4, 4, v4
    s_mul_i32 s10, s3, 320
    v_add_u32 v4, s10, v4
    s_barrier
    ds_read_b32 v5, v3
    s_waitcnt lgkmcnt(0)
    v_add_u32 v4, v4, v5
    s_mov_b32 s15, 0
L_poll_30:
    buffer_load_dwordx4 v[96:99], v4, s[56:59], 0 offen offset:0 sc1
    buffer_load_dwordx4 v[100:103], v4, s[56:59], 0 offen offset:64 sc1
    buffer_load_dwordx4 v[104:107], v4, s[56:59], 0 offen offset:128 sc1
    buffer_load_dwordx4 v[108:111], v4, s[56:59], 0 offen offset:192 sc1
    buffer_load_dwordx4 v[112:115], v4, s[56:59], 0 offen offset:256 sc1
    s_waitcnt vmcnt(0)
    v_max3_u32 v6, v96, v97, v98
    v_max3_u32 v6, v6, v99, v100
    v_max3_u32 v6, v6, v101, v102
    v_max3_u32 v6, v6, v103, v104
    v_max3_u32 v6, v6, v105, v106
    v_max3_u32 v6, v6, v107, v108
    v_max3_u32 v6, v6, v109, v110
    v_max3_u32 v6, v6, v111, v112
    v_max3_u32 v6, v6, v113, v114
    v_max_u32 v6, v6, v115
    v_cmp_eq_u32 vcc, -1, v6
    s_cbranch_vccz L_done_31
    s_sleep 1
    s_add_u32 s15, s15, 1
    s_cmp_lt_u32 s15, 200000
    s_cbranch_scc1 L_poll_30
L_done_31:
    v_mfma_f32_16x16x32_bf16 v[116:119], v[96:99], v[16:19], 0
    v_mfma_f32_16x16x32_bf16 v[120:123], v[96:99], v[20:23], 0
    v_mfma_f32_16x16x32_bf16 v[124:127], v[96:99], v[24:27], 0
    v_mfma_f32_16x16x32_bf16 v[128:131], v[96:99], v[28:31], 0
    v_mfma_f32_16x16x32_bf16 v[116:119], v[100:103], v[32:35], v[116:119]
    v_mfma_f32_16x16x32_bf16 v[120:123], v[100:103], v[36:39], v[120:123]
    v_mfma_f32_16x16x32_bf16 v[124:127], v[100:103], v[40:43], v[124:127]
    v_mfma_f32_16x16x32_bf16 v[128:131], v[100:103], v[44:47], v[128:131]
    v_mfma_f32_16x16x32_bf16 v[116:119], v[104:107], v[48:51], v[116:119]
    v_mfma_f32_16x16x32_bf16 v[120:123], v[104:107], v[52:55], v[120:123]
    v_mfma_f32_16x16x32_bf16 v[124:127], v[104:107], v[56:59], v[124:127]
    v_mfma_f32_16x16x32_bf16 v[128:131], v[104:107], v[60:63], v[128:131]
    v_mfma_f32_16x16x32_bf16 v[116:119], v[108:111], v[64:67], v[116:119]
    v_mfma_f32_16x16x32_bf16 v[120:123], v[108:111], v[68:71], v[120:123]
    v_mfma_f32_16x16x32_bf16 v[124:127], v[108:111], v[72:75], v[124:127]
    v_mfma_f32_16x16x32_bf16 v[128:131], v[108:111], v[76:79], v[128:131]
    v_mfma_f32_16x16x32_bf16 v[116:119], v[112:115], v[80:83], v[116:119]
    v_mfma_f32_16x16x32_bf16 v[120:123], v[112:115], v[84:87], v[120:123]
    v_mfma_f32_16x16x32_bf16 v[124:127], v[112:115], v[88:91], v[124:127]
    v_mfma_f32_16x16x32_bf16 v[128:131], v[112:115], v[92:95], v[128:131]
    v_and_b32 v2, 15, v1
    v_lshlrev_b32 v2, 2, v2
    s_lshl_b32 s10, s3, 9
    s_add_u32 s10, s10, 103104
    v_add_u32 v2, s10, v2
    ds_write2_b32 v2, v116, v117 offset0:0 offset1:64
    ds_write2_b32 v2, v120, v121 offset0:16 offset1:80
    ds_write2_b32 v2, v124, v125 offset0:32 offset1:96
    ds_write2_b32 v2, v128, v129 offset0:48 offset1:112
    s_waitcnt lgkmcnt(0)
    s_barrier
    s_cmp_lg_u32 s3, 0
    s_cbranch_scc1 L_fin
    v_lshrrev_b32 v2, 5, v1
    v_lshlrev_b32 v3, 8, v2
    v_and_b32 v4, 31, v1
    v_lshl_add_u32 v3, v4, 2, v3
    v_add_u32 v3, 103104, v3
    ds_read2_b32 v[8:9], v3 offset0:0 offset1:32
    ds_read2_b32 v[10:11], v3 offset0:128 offset1:160
    v_add_u32 v5, 1024, v3
    ds_read2_b32 v[12:13], v5 offset0:0 offset1:32
    ds_read2_b32 v[14:15], v5 offset0:128 offset1:160
    s_and_b32 s10, s7, 7
    s_lshr_b32 s11, s7, 3
    s_mul_i32 s14, s10, 7
    s_add_u32 s14, s14, s11
    s_cmp_eq_u32 s10, 7
    s_cselect_b32 s10, 1, 0
    s_sub_u32 s14, s14, s10
    s_lshl_b32 s14, s14, 7
    s_add_u32 s14, s14, 61440
    v_lshlrev_b32 v6, 6, v2
    v_lshl_add_u32 v6, v4, 1, v6
    v_add_u32 v6, s14, v6
    s_mov_b32 s10, 0xbfb8aa3b
    s_waitcnt lgkmcnt(0)
    v_pk_add_f32 v[8:9], v[8:9], v[10:11]
    v_pk_add_f32 v[12:13], v[12:13], v[14:15]
    v_pk_add_f32 v[8:9], v[8:9], v[12:13]
    v_cvt_pk_bf16_f32 v10, v8, v9
    v_lshlrev_b32 v8, 16, v10
    v_and_b32 v9, 0xffff0000, v10
    v_mul_f32 v10, s10, v8
    v_exp_f32 v10, v10
    s_nop 0
    v_add_f32 v10, 1.0, v10
    v_rcp_f32 v10, v10
    s_nop 0
    v_mul_f32 v8, v8, v10
    v_cvt_pk_bf16_f32 v8, v8, v8
    v_lshlrev_b32 v8, 16, v8
    v_mul_f32 v8, v8, v9
    s_nop 1
    v_mov_b32_dpp v9, v8 quad_perm:[1,0,3,2] row_mask:0xf bank_mask:0xf
    v_cvt_pk_bf16_f32 v8, v8, v9
    s_mov_b32 exec_lo, 0x55555555
    s_mov_b32 exec_hi, 0x55555555
    buffer_store_dword v8, v6, s[56:59], 0 offen sc1
    s_mov_b64 exec, -1
    s_branch L_fin
L_down:
    v_lshrrev_b32 v2, 4, v1
    v_lshlrev_b32 v2, 3, v2
    v_bfe_u32 v3, v1, 2, 2
    v_add_u32 v2, v2, v3
    s_mul_i32 s10, s3, 448
    v_add_u32 v2, s10, v2
    v_lshlrev_b32 v2, 5, v2
    v_and_b32 v3, 3, v1
    v_lshl_add_u32 v2, v3, 3, v2
    ds_read_b64_tr_b16 v[16:17], v2 offset:0
    ds_read_b64_tr_b16 v[18:19], v2 offset:128
    ds_read_b64_tr_b16 v[20:21], v2 offset:1024
    ds_read_b64_tr_b16 v[22:23], v2 offset:1152
    ds_read_b64_tr_b16 v[24:25], v2 offset:2048
    ds_read_b64_tr_b16 v[26:27], v2 offset:2176
    ds_read_b64_tr_b16 v[28:29], v2 offset:3072
    ds_read_b64_tr_b16 v[30:31], v2 offset:3200
    ds_read_b64_tr_b16 v[32:33], v2 offset:4096
    ds_read_b64_tr_b16 v[34:35], v2 offset:4224
    ds_read_b64_tr_b16 v[36:37], v2 offset:5120
    ds_read_b64_tr_b16 v[38:39], v2 offset:5248
    ds_read_b64_tr_b16 v[40:41], v2 offset:6144
    ds_read_b64_tr_b16 v[42:43], v2 offset:6272
    ds_read_b64_tr_b16 v[44:45], v2 offset:7168
    ds_read_b64_tr_b16 v[46:47], v2 offset:7296
    ds_read_b64_tr_b16 v[48:49], v2 offset:8192
    ds_read_b64_tr_b16 v[50:51], v2 offset:8320
    ds_read_b64_tr_b16 v[52:53], v2 offset:9216
    ds_read_b64_tr_b16 v[54:55], v2 offset:9344
    ds_read_b64_tr_b16 v[56:57], v2 offset:10240
    ds_read_b64_tr_b16 v[58:59], v2 offset:10368
    ds_read_b64_tr_b16 v[60:61], v2 offset:11264
    ds_read_b64_tr_b16 v[62:63], v2 offset:11392
    ds_read_b64_tr_b16 v[64:65], v2 offset:12288
    ds_read_b64_tr_b16 v[66:67], v2 offset:12416
    ds_read_b64_tr_b16 v[68:69], v2 offset:13312
    ds_read_b64_tr_b16 v[70:71], v2 offset:13440
    v_mov_b32 v240, 162756
    v_mov_b32 v241, 1
    s_lshl_b32 s10, s8, 6
    s_add_u32 s10, s10, 20480
    v_mov_b32 v242, s10
    s_waitcnt vmcnt(0)
    s_mov_b64 s[12:13], exec
    s_mov_b64 exec, 1
    ds_add_rtn_u32 v243, v240, v241
    s_waitcnt lgkmcnt(0)
    v_cmp_eq_u32 vcc, 3, v243
    s_cbranch_vccz L_f2_32
    buffer_store_dword v139, v242, s[56:59], 0 offen sc1
L_f2_32:
    s_mov_b64 exec, s[12:13]
    v_and_b32 v3, 1, v1
    v_lshlrev_b32 v3, 6, v3
    v_lshrrev_b32 v4, 4, v1
    v_lshl_add_u32 v4, v4, 4, v3
    s_mul_i32 s10, s3, 1792
    s_add_u32 s10, s10, 61440
    v_add_u32 v4, s10, v4
    s_cmp_eq_u32 s3, 3
    s_cselect_b32 s11, 2147483648, 0
    s_barrier
    s_mov_b32 s15, 0
L_poll_33:
    buffer_load_dwordx4 v[72:75], v4, s[56:59], 0 offen offset:0 sc1
    buffer_load_dwordx4 v[76:79], v4, s[56:59], 0 offen offset:128 sc1
    buffer_load_dwordx4 v[80:83], v4, s[56:59], 0 offen offset:256 sc1
    buffer_load_dwordx4 v[84:87], v4, s[56:59], 0 offen offset:384 sc1
    buffer_load_dwordx4 v[88:91], v4, s[56:59], 0 offen offset:512 sc1
    buffer_load_dwordx4 v[92:95], v4, s[56:59], 0 offen offset:640 sc1
    buffer_load_dwordx4 v[96:99], v4, s[56:59], 0 offen offset:768 sc1
    buffer_load_dwordx4 v[100:103], v4, s[56:59], 0 offen offset:896 sc1
    buffer_load_dwordx4 v[104:107], v4, s[56:59], 0 offen offset:1024 sc1
    buffer_load_dwordx4 v[108:111], v4, s[56:59], 0 offen offset:1152 sc1
    buffer_load_dwordx4 v[112:115], v4, s[56:59], 0 offen offset:1280 sc1
    buffer_load_dwordx4 v[116:119], v4, s[56:59], 0 offen offset:1408 sc1
    buffer_load_dwordx4 v[120:123], v4, s[56:59], s11 offen offset:1536 sc1
    buffer_load_dwordx4 v[124:127], v4, s[56:59], s11 offen offset:1664 sc1
    s_waitcnt vmcnt(0)
    v_max3_u32 v6, v72, v73, v74
    v_max3_u32 v6, v6, v75, v76
    v_max3_u32 v6, v6, v77, v78
    v_max3_u32 v6, v6, v79, v80
    v_max3_u32 v6, v6, v81, v82
    v_max3_u32 v6, v6, v83, v84
    v_max3_u32 v6, v6, v85, v86
    v_max3_u32 v6, v6, v87, v88
    v_max3_u32 v6, v6, v89, v90
    v_max3_u32 v6, v6, v91, v92
    v_max3_u32 v6, v6, v93, v94
    v_max3_u32 v6, v6, v95, v96
    v_max3_u32 v6, v6, v97, v98
    v_max3_u32 v6, v6, v99, v100
    v_max3_u32 v6, v6, v101, v102
    v_max3_u32 v6, v6, v103, v104
    v_max3_u32 v6, v6, v105, v106
    v_max3_u32 v6, v6, v107, v108
    v_max3_u32 v6, v6, v109, v110
    v_max3_u32 v6, v6, v111, v112
    v_max3_u32 v6, v6, v113, v114
    v_max3_u32 v6, v6, v115, v116
    v_max3_u32 v6, v6, v117, v118
    v_max3_u32 v6, v6, v119, v120
    v_max3_u32 v6, v6, v121, v122
    v_max3_u32 v6, v6, v123, v124
    v_max3_u32 v6, v6, v125, v126
    v_max_u32 v6, v6, v127
    v_cmp_eq_u32 vcc, -1, v6
    s_cbranch_vccz L_done_34
    s_sleep 4
    s_add_u32 s15, s15, 1
    s_cmp_lt_u32 s15, 200000
    s_cbranch_scc1 L_poll_33
L_done_34:
    v_mfma_f32_16x16x32_bf16 v[8:11], v[72:75], v[16:19], 0
    v_mfma_f32_16x16x32_bf16 v[8:11], v[76:79], v[20:23], v[8:11]
    v_mfma_f32_16x16x32_bf16 v[8:11], v[80:83], v[24:27], v[8:11]
    v_mfma_f32_16x16x32_bf16 v[8:11], v[84:87], v[28:31], v[8:11]
    v_mfma_f32_16x16x32_bf16 v[8:11], v[88:91], v[32:35], v[8:11]
    v_mfma_f32_16x16x32_bf16 v[8:11], v[92:95], v[36:39], v[8:11]
    v_mfma_f32_16x16x32_bf16 v[8:11], v[96:99], v[40:43], v[8:11]
    v_mfma_f32_16x16x32_bf16 v[8:11], v[100:103], v[44:47], v[8:11]
    v_mfma_f32_16x16x32_bf16 v[8:11], v[104:107], v[48:51], v[8:11]
    v_mfma_f32_16x16x32_bf16 v[8:11], v[108:111], v[52:55], v[8:11]
    v_mfma_f32_16x16x32_bf16 v[8:11], v[112:115], v[56:59], v[8:11]
    v_mfma_f32_16x16x32_bf16 v[8:11], v[116:119], v[60:63], v[8:11]
    s_cmp_eq_u32 s3, 3
    s_cbranch_scc1 L_dn_skip
    v_mfma_f32_16x16x32_bf16 v[8:11], v[120:123], v[64:67], v[8:11]
    v_mfma_f32_16x16x32_bf16 v[8:11], v[124:127], v[68:71], v[8:11]
L_dn_skip:
    v_and_b32 v2, 15, v1
    v_lshlrev_b32 v2, 4, v2
    s_lshl_b32 s10, s3, 2
    s_add_u32 s10, s10, 103104
    v_add_u32 v2, s10, v2
    s_nop 2
    ds_write2_b32 v2, v8, v9 offset0:0 offset1:64
    s_waitcnt lgkmcnt(0)
    s_barrier
    s_branch L_fin
L_row_end:
    v_mov_b32 v240, 162756
    v_mov_b32 v241, 1
    s_lshl_b32 s10, s8, 6
    s_add_u32 s10, s10, 20480
    v_mov_b32 v242, s10
    s_waitcnt vmcnt(0)
    s_mov_b64 s[12:13], exec
    s_mov_b64 exec, 1
    ds_add_rtn_u32 v243, v240, v241
    s_waitcnt lgkmcnt(0)
    v_cmp_eq_u32 vcc, 3, v243
    s_cbranch_vccz L_f2_35
    buffer_store_dword v139, v242, s[56:59], 0 offen sc1
L_f2_35:
    s_mov_b64 exec, s[12:13]
    s_branch L_fin
L_row_w4:
    s_waitcnt vmcnt(0)
    s_barrier
    s_cmp_eq_u32 s9, 1
    s_cbranch_scc1 L_fin
    s_cmp_ge_u32 s7, 94
    s_cbranch_scc1 L_fin
    s_cmp_ge_u32 s7, 54
    s_cbranch_scc1 L_down_w4
    v_lshlrev_b32 v2, 6, v1
    v_add_u32 v2, 36864, v2
    s_movk_i32 s10, 4096
    s_movk_i32 s11, 8192
    s_movk_i32 s12, 12288
    s_mov_b32 s15, 0
L_poll_36:
    buffer_load_dwordx2 v[4:5], v2, s[56:59], 0 offen sc1
    buffer_load_dwordx2 v[6:7], v2, s[56:59], s10 offen sc1
    buffer_load_dwordx2 v[8:9], v2, s[56:59], s11 offen sc1
    buffer_load_dwordx2 v[10:11], v2, s[56:59], s12 offen sc1
    s_waitcnt vmcnt(0)
    v_max3_u32 v12, v4, v5, v6
    v_max3_u32 v12, v12, v7, v8
    v_max3_u32 v12, v12, v9, v10
    v_max_u32 v12, v12, v11
    v_cmp_eq_u32 vcc, -1, v12
    s_cbranch_vccz L_done_37
    s_sleep 2
    s_add_u32 s15, s15, 1
    s_cmp_lt_u32 s15, 200000
    s_cbranch_scc1 L_poll_36
L_done_37:
    v_max3_u32 v12, v4, v6, v8
    v_max_u32 v12, v12, v10
    s_nop 1
    v_max_u32_dpp v12, v12, v12 row_shr:1 row_mask:0xf bank_mask:0xf
    s_nop 1
    v_max_u32_dpp v12, v12, v12 row_shr:2 row_mask:0xf bank_mask:0xf
    s_nop 1
    v_max_u32_dpp v12, v12, v12 row_shr:4 row_mask:0xf bank_mask:0xf
    s_nop 1
    v_max_u32_dpp v12, v12, v12 row_shr:8 row_mask:0xf bank_mask:0xf
    s_nop 1
    v_max_u32_dpp v12, v12, v12 row_bcast:15 row_mask:0xa bank_mask:0xf
    s_nop 1
    v_max_u32_dpp v12, v12, v12 row_bcast:31 row_mask:0xc bank_mask:0xf
    s_nop 0
    v_readlane_b32 s80, v12, 63
    s_nop 1
    v_cmp_eq_u32 vcc, s80, v4
    s_nop 1
    v_cndmask_b32 v4, v4, v5, vcc
    v_cmp_eq_u32 vcc, s80, v6
    s_nop 1
    v_cndmask_b32 v6, v6, v7, vcc
    v_cmp_eq_u32 vcc, s80, v8
    s_nop 1
    v_cndmask_b32 v8, v8, v9, vcc
    v_cmp_eq_u32 vcc, s80, v10
    s_nop 1
    v_cndmask_b32 v10, v10, v11, vcc
    v_max3_u32 v12, v4, v6, v8
    v_max_u32 v12, v12, v10
    s_nop 1
    v_max_u32_dpp v12, v12, v12 row_shr:1 row_mask:0xf bank_mask:0xf
    s_nop 1
    v_max_u32_dpp v12, v12, v12 row_shr:2 row_mask:0xf bank_mask:0xf
    s_nop 1
    v_max_u32_dpp v12, v12, v12 row_shr:4 row_mask:0xf bank_mask:0xf
    s_nop 1
    v_max_u32_dpp v12, v12, v12 row_shr:8 row_mask:0xf bank_mask:0xf
    s_nop 1
    v_max_u32_dpp v12, v12, v12 row_bcast:15 row_mask:0xa bank_mask:0xf
    s_nop 1
    v_max_u32_dpp v12, v12, v12 row_bcast:31 row_mask:0xc bank_mask:0xf
    s_nop 0
    v_readlane_b32 s81, v12, 63
    s_and_b32 s10, s80, 0xffff
    s_sub_u32 s10, 2047, s10
    s_and_b32 s10, s10, 2047
    s_and_b32 s11, s81, 0xffff
    s_sub_u32 s11, 2047, s11
    s_and_b32 s11, s11, 2047
    s_lshr_b32 s12, s10, 3
    s_lshr_b32 s13, s11, 3
    s_cmp_eq_u32 s12, s13
    s_cselect_b32 s14, 1280, 0
    s_mul_i32 s12, s12, 2560
    s_mul_i32 s13, s13, 2560
    s_add_u32 s13, s13, s14
    s_add_u32 s12, s12, 131072
    s_add_u32 s13, s13, 131072
    v_mov_b32 v2, 162240
    v_mov_b32 v4, s12
    v_mov_b32 v5, s13
    ds_write_b64 v2, v[4:5]
    s_waitcnt lgkmcnt(0)
    s_barrier
    s_cmp_lg_u32 s7, 0
    s_cbranch_scc1 L_nodec
    v_mov_b32 v2, 68608
    v_mov_b32 v4, s80
    v_mov_b32 v5, s81
    s_mov_b64 exec, 1
    buffer_store_dwordx2 v[4:5], v2, s[56:59], 0 offen sc1
    s_mov_b64 exec, -1
L_nodec:
    s_barrier
    s_branch L_fin
L_down_w4:
    v_mov_b32 v2, 68608
    s_mov_b32 s15, 0
L_poll_38:
    buffer_load_dwordx2 v[4:5], v2, s[56:59], 0 offen sc1
    s_waitcnt vmcnt(0)
    v_max_u32 v6, v4, v5
    v_cmp_eq_u32 vcc, -1, v6
    s_cbranch_vccz L_done_39
    s_sleep 4
    s_add_u32 s15, s15, 1
    s_cmp_lt_u32 s15, 200000
    s_cbranch_scc1 L_poll_38
L_done_39:
    v_readfirstlane_b32 s80, v4
    v_readfirstlane_b32 s81, v5
    s_barrier
    s_sub_u32 s10, s7, 54
    s_and_b32 s11, s10, 7
    s_lshr_b32 s10, s10, 3
    s_mul_i32 s82, s11, 5
    s_add_u32 s82, s82, s10
    s_and_b32 s10, s80, 0xffff
    s_sub_u32 s10, 2047, s10
    s_and_b32 s10, s10, 2047
    s_and_b32 s11, s81, 0xffff
    s_sub_u32 s11, 2047, s11
    s_and_b32 s11, s11, 2047
    s_lshr_b32 s12, s10, 3
    s_lshr_b32 s13, s11, 3
    s_cmp_eq_u32 s12, s13
    s_cselect_b32 s14, 1280, 0
    s_mul_i32 s12, s12, 2560
    s_mul_i32 s13, s13, 2560
    s_add_u32 s13, s13, s14
    v_bfe_u32 v3, v1, 4, 1
    v_cmp_eq_u32 vcc, 1, v3
    v_mov_b32 v4, s10
    v_mov_b32 v5, s11
    v_cndmask_b32 v4, v4, v5, vcc
    v_mov_b32 v5, s12
    v_mov_b32 v6, s13
    v_cndmask_b32 v5, v5, v6, vcc
    v_mov_b32 v6, s80
    v_mov_b32 v7, s81
    v_cndmask_b32 v6, v6, v7, vcc
    v_and_b32 v7, 15, v1
    v_lshlrev_b32 v7, 1, v7
    s_lshl_b32 s82, s82, 5
    v_add_u32 v7, s82, v7
    v_lshrrev_b32 v8, 3, v4
    v_lshlrev_b32 v8, 6, v8
    v_add_u32 v8, 20480, v8
    s_mov_b32 s15, 0
L_poll_40:
    buffer_load_dword v9, v8, s[56:59], 0 offen sc1
    s_waitcnt vmcnt(0)
    v_cmp_ne_u32 vcc, s4, v9
    s_cbranch_vccz L_done_41
    s_sleep 2
    s_add_u32 s15, s15, 1
    s_cmp_lt_u32 s15, 200000
    s_cbranch_scc1 L_poll_40
L_done_41:
    v_add_u32 v5, v5, v7
    s_mov_b32 s10, 131072
    s_mov_b32 s11, 786432
    s_mov_b32 s12, 59648
    buffer_load_ushort v10, v5, s[56:59], s10 offen sc1
    buffer_load_ushort v11, v5, s[56:59], s11 offen sc1
    buffer_load_ushort v12, v7, s[56:59], s12 offen sc1
    v_mul_u32_u24 v4, 1280, v4
    v_add_u32 v4, v4, v7
    v_ashrrev_i32 v13, 31, v6
    v_not_b32 v13, v13
    v_or_b32 v13, 0x80000000, v13
    v_xor_b32 v6, v6, v13
    v_and_b32 v6, 0xffff0000, v6
    s_mov_b32 s10, 0xbfb8aa3b
    v_mul_f32 v6, s10, v6
    v_exp_f32 v6, v6
    s_nop 0
    v_add_f32 v6, 1.0, v6
    v_rcp_f32 v6, v6
    s_nop 0
    v_cvt_pk_bf16_f32 v6, v6, v6
    v_lshlrev_b32 v6, 16, v6
    v_and_b32 v13, 31, v1
    v_lshlrev_b32 v13, 4, v13
    v_add_u32 v13, 103104, v13
    s_waitcnt vmcnt(0)
    v_lshlrev_b32 v10, 16, v10
    v_lshlrev_b32 v11, 16, v11
    v_lshlrev_b32 v12, 16, v12
    s_barrier
    ds_read_b128 v[16:19], v13
    s_waitcnt lgkmcnt(0)
    v_pk_add_f32 v[16:17], v[16:17], v[18:19]
    v_add_f32 v16, v16, v17
    v_cvt_pk_bf16_f32 v16, v16, v16
    v_lshlrev_b32 v16, 16, v16
    v_mul_f32 v16, v16, v6
    v_cvt_pk_bf16_f32 v16, v16, v16
    v_lshlrev_b32 v16, 16, v16
    v_add_f32 v16, v16, v10
    v_cvt_pk_bf16_f32 v16, v16, v16
    v_lshlrev_b32 v16, 16, v16
    v_mul_f32 v16, v16, v12
    v_cvt_pk_bf16_f32 v16, v16, v16
    v_lshlrev_b32 v16, 16, v16
    v_add_f32 v16, v16, v11
    v_cvt_pk_bf16_f32 v16, v16, v16
    s_mov_b32 exec_lo, -1
    s_mov_b32 exec_hi, 0
    buffer_store_short v16, v4, s[64:67], 0 offen sc1
    s_mov_b64 exec, -1
L_fin:
L_exit:
    s_endpgm
.section .rodata,"a"
.p2align 6
.amdhsa_kernel adaLN_cond__ssm_conv_h3__moe_arch_mod__prompt_kernel
  .amdhsa_next_free_vgpr 256
  .amdhsa_next_free_sgpr 102
  .amdhsa_accum_offset 256
  .amdhsa_group_segment_fixed_size 0
  .amdhsa_kernarg_size 128
  .amdhsa_user_sgpr_count 2
  .amdhsa_user_sgpr_kernarg_segment_ptr 1
  .amdhsa_system_sgpr_workgroup_id_x 1
  .amdhsa_float_denorm_mode_32 3
.end_amdhsa_kernel
```
